```python
import torch

def _softmax(x, axis=-1):
    return torch.softmax(x, dim=axis)
def _gelu(x):
    return torch.nn.functional.gelu(x, approximate="tanh")
def _silu(x):
    return torch.nn.functional.silu(x)
def _sigmoid(x):
    return torch.sigmoid(x)
def _layernorm(x, axis=-1, eps=1e-5):
    m = x.mean(dim=axis, keepdim=True)
    v = x.var(dim=axis, keepdim=True, unbiased=False)
    return (x - m) / torch.sqrt(v + eps)
def _scatter_add(tgt, idx, src, axis=0):
    return tgt.clone().index_add_(axis, idx, src)
def _segment_sum(src, seg, n):
    out = torch.zeros((n,) + src.shape[1:], dtype=src.dtype)
    return out.index_add_(0, seg, src)
def _pad(x, pw):
    flat = tuple(v for pair in reversed(pw) for v in pair)
    return torch.nn.functional.pad(x, flat)

kernel_name = 'gather_scatter__molecular_angular_gemnet__graph'

def setup_inputs():

    _w = (lambda a: (lambda t: t.to(torch.bfloat16) if t.is_floating_point() else t)(torch.as_tensor(a)))
    N, deg, De, L = 25000, 16, 16, 2
    E = N * deg
    T = E * deg
    NR = 8
    dist = torch.rand(E).to(float)
    angle = (torch.rand(T) * torch.pi).to(float)
    centers = torch.linspace(0.0, 1.0, NR).to(float)
    ang_freq = torch.arange(1, L + 1).to(float)
    return {
        "m": _w((lambda *s: torch.randn(*s, dtype=torch.bfloat16) * 0.05)(E, De)),
        "idx_in": _w((lambda lo, hi, *s: torch.randint(lo, hi, s))(0, E, T).to(torch.int64)),
        "idx_out": _w((lambda lo, hi, *s: torch.randint(lo, hi, s))(0, E, T).to(torch.int64)),
        "dist": _w(dist),
        "angle": _w(angle),
        "centers": _w(centers),
        "ang_freq": _w(ang_freq),
        "w_rbf": _w((lambda *s: torch.randn(*s, dtype=torch.bfloat16) * 0.2)(NR, De)),
        "w_sbf": _w((lambda *s: torch.randn(*s, dtype=torch.bfloat16) * 0.2)(NR * L, De)),
        "w_down": _w((lambda *s: torch.randn(*s, dtype=torch.bfloat16) * 0.2)(De, De)),
        "w_up": _w((lambda *s: torch.randn(*s, dtype=torch.bfloat16) * 0.2)(De, De)),
    }

def reference(m, idx_in, idx_out, dist, angle, centers, ang_freq, w_rbf, w_sbf, w_down, w_up):
    E, De = m.shape[0], m.shape[1]
    NR = centers.shape[0]
    L = ang_freq.shape[0]
    rbf = torch.exp(-10.0 * (dist[:, None] - centers[None, :]) ** 2)
    cbf = torch.cos(ang_freq[None, :] * angle[:, None])
    rbf_t = rbf[idx_out]
    sbf = torch.reshape(rbf_t[:, :, None] * cbf[:, None, :], (-1, NR * L))
    x = (m[idx_in] @ w_down) * (sbf @ w_sbf)
    agg = _segment_sum(x, idx_out, E)
    return m + (agg @ w_up) * (rbf @ w_rbf)
```

```asm
; @launch kernel=gs_bin_kernel grid=(256,1,1) block=(1024,1,1) lds=160272
; @launch kernel=gather_scatter__molecular_angular_gemnet__graph_kernel grid=(256,1,1) block=(1024,1,1) lds=163840
.amdgcn_target "amdgcn-amd-amdhsa--gfx950"
.text
.globl gs_bin_kernel
.p2align 8
.type gs_bin_kernel,@function
gs_bin_kernel:
    s_cmp_ge_u32 s2, 256
    s_cbranch_scc1 K1_END
    s_mov_b32 s3, TEXT_END-gs_bin_kernel-32
    s_getpc_b64 s[84:85]
    v_lshlrev_b32 v84, 7, v0
    v_mov_b32 v85, s85
    v_cmp_gt_u32 s[86:87], s3, v84
    v_add_co_u32 v84, vcc, s84, v84
    s_nop 1
    v_addc_co_u32 v85, vcc, 0, v85, vcc
    s_and_b64 exec, exec, s[86:87]
    s_cbranch_execz K1_NOCPF
    global_load_dword v82, v[84:85], off
K1_NOCPF:
    s_mov_b64 exec, -1
    s_load_dwordx4 s[4:7], s[0:1], 8
    s_load_dwordx2 s[8:9], s[0:1], 32
    s_load_dwordx2 s[10:11], s[0:1], 104
    s_load_dwordx2 s[64:65], s[0:1], 0
    s_mov_b32 s66, 12800000
    s_mov_b32 s67, 0x20000
    v_lshlrev_b32 v1, 4, v0
    v_lshlrev_b32 v2, 3, v0
    v_mov_b32 v4, 0
    v_mov_b32 v5, 0
    ds_write_b64 v2, v[4:5] offset:10272
    ds_write_b64 v2, v[4:5] offset:6144
    v_lshrrev_b32 v3, 6, v0
    s_mov_b32 s32, 2739138
    s_mov_b32 s33, 63161
    s_mov_b32 s34, -1568
    s_mov_b32 s35, 0xff000000
    v_readfirstlane_b32 s36, v3
    s_mov_b32 s41, 8192
    s_mov_b32 s42, 16384
    s_mov_b32 s43, 24576
    s_mov_b32 s44, 32768
    s_mov_b32 s45, 40960
    s_mov_b32 s46, 49152
    s_mov_b32 s47, 57344
    s_mov_b32 s48, 65536
    s_mov_b32 s49, 73728
    s_mov_b32 s50, 81920
    s_mov_b32 s51, 90112
    s_mov_b32 s52, 98304
    s_mov_b32 s53, 106496
    s_mov_b32 s54, 114688
    s_mov_b32 s55, 122880
    s_mov_b32 s56, 131072
    s_mul_i32 s3, s2, 16384
    s_mul_i32 s37, s2, 8192
    s_mul_i32 s38, s2, 150016
    s_mul_i32 s39, s2, 8192
    s_add_u32 s39, s39, 41943040
    s_mul_i32 s62, s2, 14688
    s_sub_u32 s62, 25165824, s62
    s_lshr_b32 s63, s62, 1
    v_cmp_gt_u32 vcc, 106, v0
    v_add_u32 v6, s62, v1
    v_add_u32 v7, s63, v2
    v_cndmask_b32 v6, -1, v6, vcc
    v_cndmask_b32 v7, -1, v7, vcc
    s_sub_u32 s14, 25600000, s3
    s_mov_b32 s18, s14
    s_sub_u32 s22, 12800000, s37
    s_mov_b32 s72, 2097152
    s_mov_b32 s73, 4194304
    s_mov_b32 s74, 6291456
    s_mov_b32 s75, 8388608
    s_mov_b32 s76, 10485760
    s_mov_b32 s77, 12582912
    s_mov_b32 s78, 14680064
    s_mov_b32 s79, 16777216
    s_mov_b32 s80, 18874368
    s_mov_b32 s81, 20971520
    s_mov_b32 s15, 0x20000
    s_mov_b32 s19, 0x20000
    s_mov_b32 s23, 0x20000
    s_mov_b32 s26, 150000
    s_mov_b32 s27, 0x20000
    s_mov_b32 s30, 8192
    s_mov_b32 s31, 0x20000
    s_waitcnt lgkmcnt(0)
    s_add_u32 s12, s4, s3
    s_addc_u32 s13, s5, 0
    s_add_u32 s16, s6, s3
    s_addc_u32 s17, s7, 0
    s_add_u32 s20, s8, s37
    s_addc_u32 s21, s9, 0
    s_add_u32 s24, s10, s38
    s_addc_u32 s25, s11, 0
    s_add_u32 s28, s10, s39
    s_addc_u32 s29, s11, 0
    v_mov_b32 v4, 1
    v_mov_b32 v5, 6
    v_cmp_gt_u32 vcc, 106, v0
    s_nop 0
    s_mov_b64 s[60:61], vcc
    buffer_load_dwordx4 v[8:11], v1, s[16:19], 0 offen nt sc0 sc1
    buffer_load_dwordx4 v[36:39], v1, s[12:15], 0 offen nt sc0 sc1
    buffer_load_dwordx4 v[32:35], v6, s[16:19], 0 offen nt sc0 sc1
    buffer_load_dwordx4 v[60:63], v6, s[12:15], 0 offen nt sc0 sc1
    s_barrier
    s_waitcnt vmcnt(2)
    buffer_load_dwordx4 v[12:15], v1, s[16:19], s73 offen nt sc0 sc1
    buffer_load_dwordx4 v[40:43], v1, s[12:15], s73 offen nt sc0 sc1
    v_mul_hi_u32_u24 v78, s32, v8
    v_mad_i32_i24 v80, v78, s34, v8
    v_mul_hi_u32_u24 v79, s33, v36
    v_lshl_or_b32 v8, v79, 8, v78
    v_and_b32 v81, 7, v80
    v_lshlrev_b32 v8, 2, v8
    v_lshl_or_b32 v36, v36, 5, v81
    v_lshlrev_b32 v80, 21, v80
    ds_add_u32 v8, v4 offset:10272
    v_bfi_b32 v36, s35, v80, v36
    v_mul_hi_u32_u24 v78, s32, v9
    v_mad_i32_i24 v80, v78, s34, v9
    v_mul_hi_u32_u24 v79, s33, v37
    v_lshl_or_b32 v9, v79, 8, v78
    v_and_b32 v81, 7, v80
    v_lshlrev_b32 v9, 2, v9
    v_lshl_or_b32 v37, v37, 5, v81
    v_lshlrev_b32 v80, 21, v80
    ds_add_u32 v9, v4 offset:10272
    v_bfi_b32 v37, s35, v80, v37
    v_mul_hi_u32_u24 v78, s32, v10
    v_mad_i32_i24 v80, v78, s34, v10
    v_mul_hi_u32_u24 v79, s33, v38
    v_lshl_or_b32 v10, v79, 8, v78
    v_and_b32 v81, 7, v80
    v_lshlrev_b32 v10, 2, v10
    v_lshl_or_b32 v38, v38, 5, v81
    v_lshlrev_b32 v80, 21, v80
    ds_add_u32 v10, v4 offset:10272
    v_bfi_b32 v38, s35, v80, v38
    v_mul_hi_u32_u24 v78, s32, v11
    v_mad_i32_i24 v80, v78, s34, v11
    v_mul_hi_u32_u24 v79, s33, v39
    v_lshl_or_b32 v11, v79, 8, v78
    v_and_b32 v81, 7, v80
    v_lshlrev_b32 v11, 2, v11
    v_lshl_or_b32 v39, v39, 5, v81
    v_lshlrev_b32 v80, 21, v80
    ds_add_u32 v11, v4 offset:10272
    v_bfi_b32 v39, s35, v80, v39
    s_cmp_ge_u32 s36, 2
    s_cbranch_scc1 K1_H6_1
    s_waitcnt vmcnt(2)
    s_mov_b64 exec, s[60:61]
    v_mul_hi_u32_u24 v78, s32, v32
    v_mad_i32_i24 v80, v78, s34, v32
    v_mul_hi_u32_u24 v79, s33, v60
    v_lshl_or_b32 v32, v79, 8, v78
    v_and_b32 v81, 7, v80
    v_lshlrev_b32 v32, 2, v32
    v_lshl_or_b32 v60, v60, 5, v81
    v_lshlrev_b32 v80, 21, v80
    ds_add_u32 v32, v4 offset:10272
    v_bfi_b32 v60, s35, v80, v60
    v_mul_hi_u32_u24 v78, s32, v33
    v_mad_i32_i24 v80, v78, s34, v33
    v_mul_hi_u32_u24 v79, s33, v61
    v_lshl_or_b32 v33, v79, 8, v78
    v_and_b32 v81, 7, v80
    v_lshlrev_b32 v33, 2, v33
    v_lshl_or_b32 v61, v61, 5, v81
    v_lshlrev_b32 v80, 21, v80
    ds_add_u32 v33, v4 offset:10272
    v_bfi_b32 v61, s35, v80, v61
    v_mul_hi_u32_u24 v78, s32, v34
    v_mad_i32_i24 v80, v78, s34, v34
    v_mul_hi_u32_u24 v79, s33, v62
    v_lshl_or_b32 v34, v79, 8, v78
    v_and_b32 v81, 7, v80
    v_lshlrev_b32 v34, 2, v34
    v_lshl_or_b32 v62, v62, 5, v81
    v_lshlrev_b32 v80, 21, v80
    ds_add_u32 v34, v4 offset:10272
    v_bfi_b32 v62, s35, v80, v62
    v_mul_hi_u32_u24 v78, s32, v35
    v_mad_i32_i24 v80, v78, s34, v35
    v_mul_hi_u32_u24 v79, s33, v63
    v_lshl_or_b32 v35, v79, 8, v78
    v_and_b32 v81, 7, v80
    v_lshlrev_b32 v35, 2, v35
    v_lshl_or_b32 v63, v63, 5, v81
    v_lshlrev_b32 v80, 21, v80
    ds_add_u32 v35, v4 offset:10272
    v_bfi_b32 v63, s35, v80, v63
    s_mov_b64 exec, -1
K1_H6_1:
    s_waitcnt vmcnt(0)
    buffer_load_dwordx4 v[16:19], v1, s[16:19], s75 offen nt sc0 sc1
    buffer_load_dwordx4 v[44:47], v1, s[12:15], s75 offen nt sc0 sc1
    v_mul_hi_u32_u24 v78, s32, v12
    v_mad_i32_i24 v80, v78, s34, v12
    v_mul_hi_u32_u24 v79, s33, v40
    v_lshl_or_b32 v12, v79, 8, v78
    v_and_b32 v81, 7, v80
    v_lshlrev_b32 v12, 2, v12
    v_lshl_or_b32 v40, v40, 5, v81
    v_lshlrev_b32 v80, 21, v80
    ds_add_u32 v12, v4 offset:10272
    v_bfi_b32 v40, s35, v80, v40
    v_mul_hi_u32_u24 v78, s32, v13
    v_mad_i32_i24 v80, v78, s34, v13
    v_mul_hi_u32_u24 v79, s33, v41
    v_lshl_or_b32 v13, v79, 8, v78
    v_and_b32 v81, 7, v80
    v_lshlrev_b32 v13, 2, v13
    v_lshl_or_b32 v41, v41, 5, v81
    v_lshlrev_b32 v80, 21, v80
    ds_add_u32 v13, v4 offset:10272
    v_bfi_b32 v41, s35, v80, v41
    v_mul_hi_u32_u24 v78, s32, v14
    v_mad_i32_i24 v80, v78, s34, v14
    v_mul_hi_u32_u24 v79, s33, v42
    v_lshl_or_b32 v14, v79, 8, v78
    v_and_b32 v81, 7, v80
    v_lshlrev_b32 v14, 2, v14
    v_lshl_or_b32 v42, v42, 5, v81
    v_lshlrev_b32 v80, 21, v80
    ds_add_u32 v14, v4 offset:10272
    v_bfi_b32 v42, s35, v80, v42
    v_mul_hi_u32_u24 v78, s32, v15
    v_mad_i32_i24 v80, v78, s34, v15
    v_mul_hi_u32_u24 v79, s33, v43
    v_lshl_or_b32 v15, v79, 8, v78
    v_and_b32 v81, 7, v80
    v_lshlrev_b32 v15, 2, v15
    v_lshl_or_b32 v43, v43, 5, v81
    v_lshlrev_b32 v80, 21, v80
    ds_add_u32 v15, v4 offset:10272
    v_bfi_b32 v43, s35, v80, v43
    s_waitcnt vmcnt(0)
    buffer_load_dwordx4 v[20:23], v1, s[16:19], s77 offen nt sc0 sc1
    buffer_load_dwordx4 v[48:51], v1, s[12:15], s77 offen nt sc0 sc1
    v_mul_hi_u32_u24 v78, s32, v16
    v_mad_i32_i24 v80, v78, s34, v16
    v_mul_hi_u32_u24 v79, s33, v44
    v_lshl_or_b32 v16, v79, 8, v78
    v_and_b32 v81, 7, v80
    v_lshlrev_b32 v16, 2, v16
    v_lshl_or_b32 v44, v44, 5, v81
    v_lshlrev_b32 v80, 21, v80
    ds_add_u32 v16, v4 offset:10272
    v_bfi_b32 v44, s35, v80, v44
    v_mul_hi_u32_u24 v78, s32, v17
    v_mad_i32_i24 v80, v78, s34, v17
    v_mul_hi_u32_u24 v79, s33, v45
    v_lshl_or_b32 v17, v79, 8, v78
    v_and_b32 v81, 7, v80
    v_lshlrev_b32 v17, 2, v17
    v_lshl_or_b32 v45, v45, 5, v81
    v_lshlrev_b32 v80, 21, v80
    ds_add_u32 v17, v4 offset:10272
    v_bfi_b32 v45, s35, v80, v45
    v_mul_hi_u32_u24 v78, s32, v18
    v_mad_i32_i24 v80, v78, s34, v18
    v_mul_hi_u32_u24 v79, s33, v46
    v_lshl_or_b32 v18, v79, 8, v78
    v_and_b32 v81, 7, v80
    v_lshlrev_b32 v18, 2, v18
    v_lshl_or_b32 v46, v46, 5, v81
    v_lshlrev_b32 v80, 21, v80
    ds_add_u32 v18, v4 offset:10272
    v_bfi_b32 v46, s35, v80, v46
    v_mul_hi_u32_u24 v78, s32, v19
    v_mad_i32_i24 v80, v78, s34, v19
    v_mul_hi_u32_u24 v79, s33, v47
    v_lshl_or_b32 v19, v79, 8, v78
    v_and_b32 v81, 7, v80
    v_lshlrev_b32 v19, 2, v19
    v_lshl_or_b32 v47, v47, 5, v81
    v_lshlrev_b32 v80, 21, v80
    ds_add_u32 v19, v4 offset:10272
    v_bfi_b32 v47, s35, v80, v47
    s_waitcnt vmcnt(0)
    buffer_load_dwordx4 v[24:27], v1, s[16:19], s79 offen nt sc0 sc1
    buffer_load_dwordx4 v[52:55], v1, s[12:15], s79 offen nt sc0 sc1
    v_mul_hi_u32_u24 v78, s32, v20
    v_mad_i32_i24 v80, v78, s34, v20
    v_mul_hi_u32_u24 v79, s33, v48
    v_lshl_or_b32 v20, v79, 8, v78
    v_and_b32 v81, 7, v80
    v_lshlrev_b32 v20, 2, v20
    v_lshl_or_b32 v48, v48, 5, v81
    v_lshlrev_b32 v80, 21, v80
    ds_add_u32 v20, v4 offset:10272
    v_bfi_b32 v48, s35, v80, v48
    v_mul_hi_u32_u24 v78, s32, v21
    v_mad_i32_i24 v80, v78, s34, v21
    v_mul_hi_u32_u24 v79, s33, v49
    v_lshl_or_b32 v21, v79, 8, v78
    v_and_b32 v81, 7, v80
    v_lshlrev_b32 v21, 2, v21
    v_lshl_or_b32 v49, v49, 5, v81
    v_lshlrev_b32 v80, 21, v80
    ds_add_u32 v21, v4 offset:10272
    v_bfi_b32 v49, s35, v80, v49
    v_mul_hi_u32_u24 v78, s32, v22
    v_mad_i32_i24 v80, v78, s34, v22
    v_mul_hi_u32_u24 v79, s33, v50
    v_lshl_or_b32 v22, v79, 8, v78
    v_and_b32 v81, 7, v80
    v_lshlrev_b32 v22, 2, v22
    v_lshl_or_b32 v50, v50, 5, v81
    v_lshlrev_b32 v80, 21, v80
    ds_add_u32 v22, v4 offset:10272
    v_bfi_b32 v50, s35, v80, v50
    v_mul_hi_u32_u24 v78, s32, v23
    v_mad_i32_i24 v80, v78, s34, v23
    v_mul_hi_u32_u24 v79, s33, v51
    v_lshl_or_b32 v23, v79, 8, v78
    v_and_b32 v81, 7, v80
    v_lshlrev_b32 v23, 2, v23
    v_lshl_or_b32 v51, v51, 5, v81
    v_lshlrev_b32 v80, 21, v80
    ds_add_u32 v23, v4 offset:10272
    v_bfi_b32 v51, s35, v80, v51
    s_waitcnt vmcnt(0)
    buffer_load_dwordx4 v[28:31], v1, s[16:19], s81 offen nt sc0 sc1
    buffer_load_dwordx4 v[56:59], v1, s[12:15], s81 offen nt sc0 sc1
    v_mul_hi_u32_u24 v78, s32, v24
    v_mad_i32_i24 v80, v78, s34, v24
    v_mul_hi_u32_u24 v79, s33, v52
    v_lshl_or_b32 v24, v79, 8, v78
    v_and_b32 v81, 7, v80
    v_lshlrev_b32 v24, 2, v24
    v_lshl_or_b32 v52, v52, 5, v81
    v_lshlrev_b32 v80, 21, v80
    ds_add_u32 v24, v4 offset:10272
    v_bfi_b32 v52, s35, v80, v52
    v_mul_hi_u32_u24 v78, s32, v25
    v_mad_i32_i24 v80, v78, s34, v25
    v_mul_hi_u32_u24 v79, s33, v53
    v_lshl_or_b32 v25, v79, 8, v78
    v_and_b32 v81, 7, v80
    v_lshlrev_b32 v25, 2, v25
    v_lshl_or_b32 v53, v53, 5, v81
    v_lshlrev_b32 v80, 21, v80
    ds_add_u32 v25, v4 offset:10272
    v_bfi_b32 v53, s35, v80, v53
    v_mul_hi_u32_u24 v78, s32, v26
    v_mad_i32_i24 v80, v78, s34, v26
    v_mul_hi_u32_u24 v79, s33, v54
    v_lshl_or_b32 v26, v79, 8, v78
    v_and_b32 v81, 7, v80
    v_lshlrev_b32 v26, 2, v26
    v_lshl_or_b32 v54, v54, 5, v81
    v_lshlrev_b32 v80, 21, v80
    ds_add_u32 v26, v4 offset:10272
    v_bfi_b32 v54, s35, v80, v54
    v_mul_hi_u32_u24 v78, s32, v27
    v_mad_i32_i24 v80, v78, s34, v27
    v_mul_hi_u32_u24 v79, s33, v55
    v_lshl_or_b32 v27, v79, 8, v78
    v_and_b32 v81, 7, v80
    v_lshlrev_b32 v27, 2, v27
    v_lshl_or_b32 v55, v55, 5, v81
    v_lshlrev_b32 v80, 21, v80
    ds_add_u32 v27, v4 offset:10272
    v_bfi_b32 v55, s35, v80, v55
    s_waitcnt vmcnt(0)
    v_mul_hi_u32_u24 v78, s32, v28
    v_mad_i32_i24 v80, v78, s34, v28
    v_mul_hi_u32_u24 v79, s33, v56
    v_lshl_or_b32 v28, v79, 8, v78
    v_and_b32 v81, 7, v80
    v_lshlrev_b32 v28, 2, v28
    v_lshl_or_b32 v56, v56, 5, v81
    v_lshlrev_b32 v80, 21, v80
    ds_add_u32 v28, v4 offset:10272
    v_bfi_b32 v56, s35, v80, v56
    v_mul_hi_u32_u24 v78, s32, v29
    v_mad_i32_i24 v80, v78, s34, v29
    v_mul_hi_u32_u24 v79, s33, v57
    v_lshl_or_b32 v29, v79, 8, v78
    v_and_b32 v81, 7, v80
    v_lshlrev_b32 v29, 2, v29
    v_lshl_or_b32 v57, v57, 5, v81
    v_lshlrev_b32 v80, 21, v80
    ds_add_u32 v29, v4 offset:10272
    v_bfi_b32 v57, s35, v80, v57
    v_mul_hi_u32_u24 v78, s32, v30
    v_mad_i32_i24 v80, v78, s34, v30
    v_mul_hi_u32_u24 v79, s33, v58
    v_lshl_or_b32 v30, v79, 8, v78
    v_and_b32 v81, 7, v80
    v_lshlrev_b32 v30, 2, v30
    v_lshl_or_b32 v58, v58, 5, v81
    v_lshlrev_b32 v80, 21, v80
    ds_add_u32 v30, v4 offset:10272
    v_bfi_b32 v58, s35, v80, v58
    v_mul_hi_u32_u24 v78, s32, v31
    v_mad_i32_i24 v80, v78, s34, v31
    v_mul_hi_u32_u24 v79, s33, v59
    v_lshl_or_b32 v31, v79, 8, v78
    v_and_b32 v81, 7, v80
    v_lshlrev_b32 v31, 2, v31
    v_lshl_or_b32 v59, v59, 5, v81
    v_lshlrev_b32 v80, 21, v80
    ds_add_u32 v31, v4 offset:10272
    v_bfi_b32 v59, s35, v80, v59
    s_waitcnt lgkmcnt(0)
    s_barrier
    s_cmp_ge_u32 s36, 6
    s_cbranch_scc1 K1_SCANDONE
    v_and_b32 v78, 63, v0
    v_lshlrev_b32 v78, 4, v78
    ds_read_b128 v[84:87], v1 offset:10272
    ds_read_b128 v[88:91], v78 offset:10272
    ds_read_b128 v[92:95], v78 offset:11296
    ds_read_b128 v[96:99], v78 offset:12320
    ds_read_b128 v[100:103], v78 offset:13344
    ds_read_b128 v[104:107], v78 offset:14368
    s_waitcnt lgkmcnt(0)
    v_mov_b32 v79, 0
    s_cmp_gt_u32 s36, 0
    s_cselect_b32 s62, 0x10000, 0
    v_add3_u32 v88, v88, v89, v90
    v_add_u32 v88, v88, v91
    v_mad_u32_u24 v79, v88, s62, v79
    s_cmp_gt_u32 s36, 1
    s_cselect_b32 s62, 0x10000, 0
    v_add3_u32 v92, v92, v93, v94
    v_add_u32 v92, v92, v95
    v_mad_u32_u24 v79, v92, s62, v79
    s_cmp_gt_u32 s36, 2
    s_cselect_b32 s62, 0x10000, 0
    v_add3_u32 v96, v96, v97, v98
    v_add_u32 v96, v96, v99
    v_mad_u32_u24 v79, v96, s62, v79
    s_cmp_gt_u32 s36, 3
    s_cselect_b32 s62, 0x10000, 0
    v_add3_u32 v100, v100, v101, v102
    v_add_u32 v100, v100, v103
    v_mad_u32_u24 v79, v100, s62, v79
    s_cmp_gt_u32 s36, 4
    s_cselect_b32 s62, 0x10000, 0
    v_add3_u32 v104, v104, v105, v106
    v_add_u32 v104, v104, v107
    v_mad_u32_u24 v79, v104, s62, v79
    v_add3_u32 v80, v84, v85, v86
    v_add_u32 v80, v80, v87
    v_add_u32 v79, v79, v80
    s_nop 1
    v_add_u32_dpp v79, v79, v79 row_shr:1 row_mask:0xf bank_mask:0xf bound_ctrl:0
    s_nop 1
    v_add_u32_dpp v79, v79, v79 row_shr:2 row_mask:0xf bank_mask:0xf bound_ctrl:0
    s_nop 1
    v_add_u32_dpp v79, v79, v79 row_shr:4 row_mask:0xf bank_mask:0xf bound_ctrl:0
    s_nop 1
    v_add_u32_dpp v79, v79, v79 row_shr:8 row_mask:0xf bank_mask:0xf bound_ctrl:0
    s_nop 1
    v_add_u32_dpp v79, v79, v79 row_bcast:15 row_mask:0xa bank_mask:0xf
    s_nop 1
    v_add_u32_dpp v79, v79, v79 row_bcast:31 row_mask:0xc bank_mask:0xf
    s_nop 0
    v_readlane_b32 s62, v79, 63
    v_and_b32 v79, 0xffff, v79
    s_lshr_b32 s62, s62, 16
    v_sub_u32 v79, v79, v80
    v_add_u32 v88, s62, v79
    v_add_u32 v89, v88, v84
    v_add_u32 v90, v89, v85
    v_add_u32 v91, v90, v86
    v_add_u32 v92, v91, v87
    v_mov_b32 v81, 10270
    s_lshl_b32 s62, s36, 1
    v_mad_u32_u24 v84, v88, 6, v81
    v_mad_u32_u24 v85, v89, 6, v81
    v_mad_u32_u24 v86, v90, 6, v81
    v_mad_u32_u24 v87, v91, 6, v81
    v_lshl_add_u32 v78, v78, 2, s62
    ds_write_b128 v1, v[84:87]
    ds_write_b16 v78, v88 offset:6144
    ds_write_b16 v78, v89 offset:6160
    ds_write_b16 v78, v90 offset:6176
    ds_write_b16 v78, v91 offset:6192
    ds_write_b16 v78, v92 offset:6208
    s_waitcnt lgkmcnt(0)
K1_SCANDONE:
    buffer_load_dwordx2 v[64:65], v2, s[20:23], 0 offen nt sc0 sc1
    buffer_load_dwordx2 v[66:67], v2, s[20:23], s72 offen nt sc0 sc1
    buffer_load_dwordx2 v[68:69], v2, s[20:23], s73 offen nt sc0 sc1
    buffer_load_dwordx2 v[70:71], v2, s[20:23], s74 offen nt sc0 sc1
    buffer_load_dwordx2 v[72:73], v2, s[20:23], s75 offen nt sc0 sc1
    buffer_load_dwordx2 v[74:75], v2, s[20:23], s76 offen nt sc0 sc1
    buffer_load_dwordx2 v[76:77], v7, s[20:23], 0 offen nt sc0 sc1
    s_barrier
    s_mov_b32 s59, 75814
    ds_add_rtn_u32 v8, v8, v5
    ds_add_rtn_u32 v9, v9, v5
    ds_add_rtn_u32 v10, v10, v5
    ds_add_rtn_u32 v11, v11, v5
    ds_add_rtn_u32 v12, v12, v5
    ds_add_rtn_u32 v13, v13, v5
    ds_add_rtn_u32 v14, v14, v5
    ds_add_rtn_u32 v15, v15, v5
    ds_add_rtn_u32 v16, v16, v5
    ds_add_rtn_u32 v17, v17, v5
    ds_add_rtn_u32 v18, v18, v5
    ds_add_rtn_u32 v19, v19, v5
    s_waitcnt lgkmcnt(8)
    v_and_b32 v80, -4, v8
    v_cmpx_gt_u32 vcc, s59, v8
    ds_write_b32 v80, v36 offset:4
    s_mov_b64 exec, -1
    v_and_b32 v78, -4, v9
    v_cmpx_gt_u32 vcc, s59, v9
    ds_write_b32 v78, v37 offset:4
    s_mov_b64 exec, -1
    v_and_b32 v80, -4, v10
    v_cmpx_gt_u32 vcc, s59, v10
    ds_write_b32 v80, v38 offset:4
    s_mov_b64 exec, -1
    v_and_b32 v78, -4, v11
    v_cmpx_gt_u32 vcc, s59, v11
    ds_write_b32 v78, v39 offset:4
    s_mov_b64 exec, -1
    ds_add_rtn_u32 v20, v20, v5
    ds_add_rtn_u32 v21, v21, v5
    ds_add_rtn_u32 v22, v22, v5
    ds_add_rtn_u32 v23, v23, v5
    s_waitcnt lgkmcnt(8)
    v_and_b32 v80, -4, v12
    v_cmpx_gt_u32 vcc, s59, v12
    ds_write_b32 v80, v40 offset:4
    s_mov_b64 exec, -1
    v_and_b32 v78, -4, v13
    v_cmpx_gt_u32 vcc, s59, v13
    ds_write_b32 v78, v41 offset:4
    s_mov_b64 exec, -1
    v_and_b32 v80, -4, v14
    v_cmpx_gt_u32 vcc, s59, v14
    ds_write_b32 v80, v42 offset:4
    s_mov_b64 exec, -1
    v_and_b32 v78, -4, v15
    v_cmpx_gt_u32 vcc, s59, v15
    ds_write_b32 v78, v43 offset:4
    s_mov_b64 exec, -1
    ds_add_rtn_u32 v24, v24, v5
    ds_add_rtn_u32 v25, v25, v5
    ds_add_rtn_u32 v26, v26, v5
    ds_add_rtn_u32 v27, v27, v5
    s_waitcnt lgkmcnt(8)
    v_and_b32 v80, -4, v16
    v_cmpx_gt_u32 vcc, s59, v16
    ds_write_b32 v80, v44 offset:4
    s_mov_b64 exec, -1
    v_and_b32 v78, -4, v17
    v_cmpx_gt_u32 vcc, s59, v17
    ds_write_b32 v78, v45 offset:4
    s_mov_b64 exec, -1
    v_and_b32 v80, -4, v18
    v_cmpx_gt_u32 vcc, s59, v18
    ds_write_b32 v80, v46 offset:4
    s_mov_b64 exec, -1
    v_and_b32 v78, -4, v19
    v_cmpx_gt_u32 vcc, s59, v19
    ds_write_b32 v78, v47 offset:4
    s_mov_b64 exec, -1
    ds_add_rtn_u32 v28, v28, v5
    ds_add_rtn_u32 v29, v29, v5
    ds_add_rtn_u32 v30, v30, v5
    ds_add_rtn_u32 v31, v31, v5
    s_waitcnt lgkmcnt(8)
    v_and_b32 v80, -4, v20
    v_cmpx_gt_u32 vcc, s59, v20
    ds_write_b32 v80, v48 offset:4
    s_mov_b64 exec, -1
    v_and_b32 v78, -4, v21
    v_cmpx_gt_u32 vcc, s59, v21
    ds_write_b32 v78, v49 offset:4
    s_mov_b64 exec, -1
    v_and_b32 v80, -4, v22
    v_cmpx_gt_u32 vcc, s59, v22
    ds_write_b32 v80, v50 offset:4
    s_mov_b64 exec, -1
    v_and_b32 v78, -4, v23
    v_cmpx_gt_u32 vcc, s59, v23
    ds_write_b32 v78, v51 offset:4
    s_mov_b64 exec, -1
    s_waitcnt lgkmcnt(4)
    v_and_b32 v80, -4, v24
    v_cmpx_gt_u32 vcc, s59, v24
    ds_write_b32 v80, v52 offset:4
    s_mov_b64 exec, -1
    v_and_b32 v78, -4, v25
    v_cmpx_gt_u32 vcc, s59, v25
    ds_write_b32 v78, v53 offset:4
    s_mov_b64 exec, -1
    v_and_b32 v80, -4, v26
    v_cmpx_gt_u32 vcc, s59, v26
    ds_write_b32 v80, v54 offset:4
    s_mov_b64 exec, -1
    v_and_b32 v78, -4, v27
    v_cmpx_gt_u32 vcc, s59, v27
    ds_write_b32 v78, v55 offset:4
    s_mov_b64 exec, -1
    s_mul_i32 s62, s2, 50000
    s_and_b32 s62, s62, -128
    v_lshl_add_u32 v83, v0, 7, s62
    v_cmp_gt_u32 vcc, 392, v0
    s_nop 1
    v_cndmask_b32 v83, -1, v83, vcc
    buffer_load_dword v82, v83, s[64:67], 0 offen
    s_waitcnt lgkmcnt(0)
    v_and_b32 v80, -4, v28
    v_cmpx_gt_u32 vcc, s59, v28
    ds_write_b32 v80, v56 offset:4
    s_mov_b64 exec, -1
    v_and_b32 v78, -4, v29
    v_cmpx_gt_u32 vcc, s59, v29
    ds_write_b32 v78, v57 offset:4
    s_mov_b64 exec, -1
    v_and_b32 v80, -4, v30
    v_cmpx_gt_u32 vcc, s59, v30
    ds_write_b32 v80, v58 offset:4
    s_mov_b64 exec, -1
    v_and_b32 v78, -4, v31
    v_cmpx_gt_u32 vcc, s59, v31
    ds_write_b32 v78, v59 offset:4
    s_mov_b64 exec, -1
    s_waitcnt vmcnt(7)
    v_and_b32 v81, 2, v8
    v_lshl_add_u32 v81, v81, 1, v8
    v_cmpx_gt_u32 vcc, s59, v8
    ds_write_b16 v81, v64 offset:2
    s_mov_b64 exec, -1
    v_and_b32 v79, 2, v9
    v_lshl_add_u32 v79, v79, 1, v9
    v_cmpx_gt_u32 vcc, s59, v9
    ds_write_b16_d16_hi v79, v64 offset:2
    s_mov_b64 exec, -1
    v_and_b32 v81, 2, v10
    v_lshl_add_u32 v81, v81, 1, v10
    v_cmpx_gt_u32 vcc, s59, v10
    ds_write_b16 v81, v65 offset:2
    s_mov_b64 exec, -1
    v_and_b32 v79, 2, v11
    v_lshl_add_u32 v79, v79, 1, v11
    v_cmpx_gt_u32 vcc, s59, v11
    ds_write_b16_d16_hi v79, v65 offset:2
    s_mov_b64 exec, -1
    s_waitcnt vmcnt(6)
    v_and_b32 v81, 2, v12
    v_lshl_add_u32 v81, v81, 1, v12
    v_cmpx_gt_u32 vcc, s59, v12
    ds_write_b16 v81, v66 offset:2
    s_mov_b64 exec, -1
    v_and_b32 v79, 2, v13
    v_lshl_add_u32 v79, v79, 1, v13
    v_cmpx_gt_u32 vcc, s59, v13
    ds_write_b16_d16_hi v79, v66 offset:2
    s_mov_b64 exec, -1
    v_and_b32 v81, 2, v14
    v_lshl_add_u32 v81, v81, 1, v14
    v_cmpx_gt_u32 vcc, s59, v14
    ds_write_b16 v81, v67 offset:2
    s_mov_b64 exec, -1
    v_and_b32 v79, 2, v15
    v_lshl_add_u32 v79, v79, 1, v15
    v_cmpx_gt_u32 vcc, s59, v15
    ds_write_b16_d16_hi v79, v67 offset:2
    s_mov_b64 exec, -1
    s_waitcnt vmcnt(5)
    v_and_b32 v81, 2, v16
    v_lshl_add_u32 v81, v81, 1, v16
    v_cmpx_gt_u32 vcc, s59, v16
    ds_write_b16 v81, v68 offset:2
    s_mov_b64 exec, -1
    v_and_b32 v79, 2, v17
    v_lshl_add_u32 v79, v79, 1, v17
    v_cmpx_gt_u32 vcc, s59, v17
    ds_write_b16_d16_hi v79, v68 offset:2
    s_mov_b64 exec, -1
    v_and_b32 v81, 2, v18
    v_lshl_add_u32 v81, v81, 1, v18
    v_cmpx_gt_u32 vcc, s59, v18
    ds_write_b16 v81, v69 offset:2
    s_mov_b64 exec, -1
    v_and_b32 v79, 2, v19
    v_lshl_add_u32 v79, v79, 1, v19
    v_cmpx_gt_u32 vcc, s59, v19
    ds_write_b16_d16_hi v79, v69 offset:2
    s_mov_b64 exec, -1
    s_waitcnt vmcnt(4)
    v_and_b32 v81, 2, v20
    v_lshl_add_u32 v81, v81, 1, v20
    v_cmpx_gt_u32 vcc, s59, v20
    ds_write_b16 v81, v70 offset:2
    s_mov_b64 exec, -1
    v_and_b32 v79, 2, v21
    v_lshl_add_u32 v79, v79, 1, v21
    v_cmpx_gt_u32 vcc, s59, v21
    ds_write_b16_d16_hi v79, v70 offset:2
    s_mov_b64 exec, -1
    v_and_b32 v81, 2, v22
    v_lshl_add_u32 v81, v81, 1, v22
    v_cmpx_gt_u32 vcc, s59, v22
    ds_write_b16 v81, v71 offset:2
    s_mov_b64 exec, -1
    v_and_b32 v79, 2, v23
    v_lshl_add_u32 v79, v79, 1, v23
    v_cmpx_gt_u32 vcc, s59, v23
    ds_write_b16_d16_hi v79, v71 offset:2
    s_mov_b64 exec, -1
    s_waitcnt vmcnt(3)
    v_and_b32 v81, 2, v24
    v_lshl_add_u32 v81, v81, 1, v24
    v_cmpx_gt_u32 vcc, s59, v24
    ds_write_b16 v81, v72 offset:2
    s_mov_b64 exec, -1
    v_and_b32 v79, 2, v25
    v_lshl_add_u32 v79, v79, 1, v25
    v_cmpx_gt_u32 vcc, s59, v25
    ds_write_b16_d16_hi v79, v72 offset:2
    s_mov_b64 exec, -1
    v_and_b32 v81, 2, v26
    v_lshl_add_u32 v81, v81, 1, v26
    v_cmpx_gt_u32 vcc, s59, v26
    ds_write_b16 v81, v73 offset:2
    s_mov_b64 exec, -1
    v_and_b32 v79, 2, v27
    v_lshl_add_u32 v79, v79, 1, v27
    v_cmpx_gt_u32 vcc, s59, v27
    ds_write_b16_d16_hi v79, v73 offset:2
    s_mov_b64 exec, -1
    s_waitcnt vmcnt(2)
    v_and_b32 v81, 2, v28
    v_lshl_add_u32 v81, v81, 1, v28
    v_cmpx_gt_u32 vcc, s59, v28
    ds_write_b16 v81, v74 offset:2
    s_mov_b64 exec, -1
    v_and_b32 v79, 2, v29
    v_lshl_add_u32 v79, v79, 1, v29
    v_cmpx_gt_u32 vcc, s59, v29
    ds_write_b16_d16_hi v79, v74 offset:2
    s_mov_b64 exec, -1
    v_and_b32 v81, 2, v30
    v_lshl_add_u32 v81, v81, 1, v30
    v_cmpx_gt_u32 vcc, s59, v30
    ds_write_b16 v81, v75 offset:2
    s_mov_b64 exec, -1
    v_and_b32 v79, 2, v31
    v_lshl_add_u32 v79, v79, 1, v31
    v_cmpx_gt_u32 vcc, s59, v31
    ds_write_b16_d16_hi v79, v75 offset:2
    s_mov_b64 exec, -1
    s_waitcnt vmcnt(1)
    s_sub_u32 s62, s36, 2
    s_cmp_ge_u32 s62, 8
    s_cbranch_scc1 K1_TDONE
    v_subrev_u32 v78, 2048, v1
    v_lshrrev_b32 v79, 5, v78
    v_and_b32 v80, 1, v0
    v_lshlrev_b32 v79, 4, v79
    v_lshl_add_u32 v79, v80, 2, v79
    v_add_u32 v79, 6144, v79
    ds_read2_b32 v[84:85], v79 offset0:0 offset1:2
    ds_read2_b32 v[86:87], v79 offset0:4 offset1:6
    s_mov_b32 s62, 0x05040100
    s_mov_b32 s63, 0x07060302
    s_waitcnt lgkmcnt(0)
    v_perm_b32 v88, v86, v84, s62
    v_perm_b32 v89, v87, v85, s62
    v_perm_b32 v90, v86, v84, s63
    v_perm_b32 v91, v87, v85, s63
    buffer_store_dwordx4 v[88:91], v78, s[28:31], 0 offen sc0 sc1
K1_TDONE:
    s_cmp_ge_u32 s36, 2
    s_cbranch_scc1 K1_S6
    s_mov_b64 exec, s[60:61]
    ds_add_rtn_u32 v32, v32, v5
    ds_add_rtn_u32 v33, v33, v5
    ds_add_rtn_u32 v34, v34, v5
    ds_add_rtn_u32 v35, v35, v5
    s_waitcnt lgkmcnt(0)
    v_and_b32 v80, -4, v32
    v_and_b32 v81, 2, v32
    ds_write_b32 v80, v60 offset:4
    v_lshl_add_u32 v32, v81, 1, v32
    v_and_b32 v78, -4, v33
    v_and_b32 v79, 2, v33
    ds_write_b32 v78, v61 offset:4
    v_lshl_add_u32 v33, v79, 1, v33
    v_and_b32 v80, -4, v34
    v_and_b32 v81, 2, v34
    ds_write_b32 v80, v62 offset:4
    v_lshl_add_u32 v34, v81, 1, v34
    v_and_b32 v78, -4, v35
    v_and_b32 v79, 2, v35
    ds_write_b32 v78, v63 offset:4
    v_lshl_add_u32 v35, v79, 1, v35
    ds_write_b16 v32, v76 offset:2
    ds_write_b16_d16_hi v33, v76 offset:2
    ds_write_b16 v34, v77 offset:2
    ds_write_b16_d16_hi v35, v77 offset:2
    s_mov_b64 exec, -1
K1_S6:
    v_add_u32 v2, 10272, v1
    v_add_u32 v3, 75808, v1
    v_add_u32 v4, 141344, v1
    v_add_u32 v5, 147456, v1
    s_waitcnt lgkmcnt(0)
    s_barrier
    ds_read_b128 v[84:87], v2 offset:0
    ds_read_b128 v[88:91], v2 offset:16384
    ds_read_b128 v[92:95], v2 offset:32768
    ds_read_b128 v[96:99], v2 offset:49152
    s_waitcnt lgkmcnt(0)
    buffer_store_dwordx4 v[84:87], v1, s[24:27], 0 offen sc0 sc1
    v_and_b32 v80, -4, v8
    v_cmpx_le_u32 vcc, s59, v8
    ds_write_b32 v80, v36 offset:4
    s_mov_b64 exec, -1
    v_and_b32 v78, -4, v9
    v_cmpx_le_u32 vcc, s59, v9
    ds_write_b32 v78, v37 offset:4
    s_mov_b64 exec, -1
    v_and_b32 v80, -4, v10
    v_cmpx_le_u32 vcc, s59, v10
    ds_write_b32 v80, v38 offset:4
    s_mov_b64 exec, -1
    v_and_b32 v78, -4, v11
    v_cmpx_le_u32 vcc, s59, v11
    ds_write_b32 v78, v39 offset:4
    s_mov_b64 exec, -1
    v_and_b32 v81, 2, v8
    v_lshl_add_u32 v81, v81, 1, v8
    v_cmpx_le_u32 vcc, s59, v8
    ds_write_b16 v81, v64 offset:2
    s_mov_b64 exec, -1
    v_and_b32 v79, 2, v9
    v_lshl_add_u32 v79, v79, 1, v9
    v_cmpx_le_u32 vcc, s59, v9
    ds_write_b16_d16_hi v79, v64 offset:2
    s_mov_b64 exec, -1
    v_and_b32 v81, 2, v10
    v_lshl_add_u32 v81, v81, 1, v10
    v_cmpx_le_u32 vcc, s59, v10
    ds_write_b16 v81, v65 offset:2
    s_mov_b64 exec, -1
    v_and_b32 v79, 2, v11
    v_lshl_add_u32 v79, v79, 1, v11
    v_cmpx_le_u32 vcc, s59, v11
    ds_write_b16_d16_hi v79, v65 offset:2
    s_mov_b64 exec, -1
    buffer_store_dwordx4 v[88:91], v1, s[24:27], s42 offen sc0 sc1
    v_and_b32 v80, -4, v12
    v_cmpx_le_u32 vcc, s59, v12
    ds_write_b32 v80, v40 offset:4
    s_mov_b64 exec, -1
    v_and_b32 v78, -4, v13
    v_cmpx_le_u32 vcc, s59, v13
    ds_write_b32 v78, v41 offset:4
    s_mov_b64 exec, -1
    v_and_b32 v80, -4, v14
    v_cmpx_le_u32 vcc, s59, v14
    ds_write_b32 v80, v42 offset:4
    s_mov_b64 exec, -1
    v_and_b32 v78, -4, v15
    v_cmpx_le_u32 vcc, s59, v15
    ds_write_b32 v78, v43 offset:4
    s_mov_b64 exec, -1
    v_and_b32 v81, 2, v12
    v_lshl_add_u32 v81, v81, 1, v12
    v_cmpx_le_u32 vcc, s59, v12
    ds_write_b16 v81, v66 offset:2
    s_mov_b64 exec, -1
    v_and_b32 v79, 2, v13
    v_lshl_add_u32 v79, v79, 1, v13
    v_cmpx_le_u32 vcc, s59, v13
    ds_write_b16_d16_hi v79, v66 offset:2
    s_mov_b64 exec, -1
    v_and_b32 v81, 2, v14
    v_lshl_add_u32 v81, v81, 1, v14
    v_cmpx_le_u32 vcc, s59, v14
    ds_write_b16 v81, v67 offset:2
    s_mov_b64 exec, -1
    v_and_b32 v79, 2, v15
    v_lshl_add_u32 v79, v79, 1, v15
    v_cmpx_le_u32 vcc, s59, v15
    ds_write_b16_d16_hi v79, v67 offset:2
    s_mov_b64 exec, -1
    buffer_store_dwordx4 v[92:95], v1, s[24:27], s44 offen sc0 sc1
    v_and_b32 v80, -4, v16
    v_cmpx_le_u32 vcc, s59, v16
    ds_write_b32 v80, v44 offset:4
    s_mov_b64 exec, -1
    v_and_b32 v78, -4, v17
    v_cmpx_le_u32 vcc, s59, v17
    ds_write_b32 v78, v45 offset:4
    s_mov_b64 exec, -1
    v_and_b32 v80, -4, v18
    v_cmpx_le_u32 vcc, s59, v18
    ds_write_b32 v80, v46 offset:4
    s_mov_b64 exec, -1
    v_and_b32 v78, -4, v19
    v_cmpx_le_u32 vcc, s59, v19
    ds_write_b32 v78, v47 offset:4
    s_mov_b64 exec, -1
    v_and_b32 v81, 2, v16
    v_lshl_add_u32 v81, v81, 1, v16
    v_cmpx_le_u32 vcc, s59, v16
    ds_write_b16 v81, v68 offset:2
    s_mov_b64 exec, -1
    v_and_b32 v79, 2, v17
    v_lshl_add_u32 v79, v79, 1, v17
    v_cmpx_le_u32 vcc, s59, v17
    ds_write_b16_d16_hi v79, v68 offset:2
    s_mov_b64 exec, -1
    v_and_b32 v81, 2, v18
    v_lshl_add_u32 v81, v81, 1, v18
    v_cmpx_le_u32 vcc, s59, v18
    ds_write_b16 v81, v69 offset:2
    s_mov_b64 exec, -1
    v_and_b32 v79, 2, v19
    v_lshl_add_u32 v79, v79, 1, v19
    v_cmpx_le_u32 vcc, s59, v19
    ds_write_b16_d16_hi v79, v69 offset:2
    s_mov_b64 exec, -1
    buffer_store_dwordx4 v[96:99], v1, s[24:27], s46 offen sc0 sc1
    v_and_b32 v80, -4, v20
    v_cmpx_le_u32 vcc, s59, v20
    ds_write_b32 v80, v48 offset:4
    s_mov_b64 exec, -1
    v_and_b32 v78, -4, v21
    v_cmpx_le_u32 vcc, s59, v21
    ds_write_b32 v78, v49 offset:4
    s_mov_b64 exec, -1
    v_and_b32 v80, -4, v22
    v_cmpx_le_u32 vcc, s59, v22
    ds_write_b32 v80, v50 offset:4
    s_mov_b64 exec, -1
    v_and_b32 v78, -4, v23
    v_cmpx_le_u32 vcc, s59, v23
    ds_write_b32 v78, v51 offset:4
    s_mov_b64 exec, -1
    v_and_b32 v81, 2, v20
    v_lshl_add_u32 v81, v81, 1, v20
    v_cmpx_le_u32 vcc, s59, v20
    ds_write_b16 v81, v70 offset:2
    s_mov_b64 exec, -1
    v_and_b32 v79, 2, v21
    v_lshl_add_u32 v79, v79, 1, v21
    v_cmpx_le_u32 vcc, s59, v21
    ds_write_b16_d16_hi v79, v70 offset:2
    s_mov_b64 exec, -1
    v_and_b32 v81, 2, v22
    v_lshl_add_u32 v81, v81, 1, v22
    v_cmpx_le_u32 vcc, s59, v22
    ds_write_b16 v81, v71 offset:2
    s_mov_b64 exec, -1
    v_and_b32 v79, 2, v23
    v_lshl_add_u32 v79, v79, 1, v23
    v_cmpx_le_u32 vcc, s59, v23
    ds_write_b16_d16_hi v79, v71 offset:2
    s_mov_b64 exec, -1
    v_and_b32 v80, -4, v24
    v_cmpx_le_u32 vcc, s59, v24
    ds_write_b32 v80, v52 offset:4
    s_mov_b64 exec, -1
    v_and_b32 v78, -4, v25
    v_cmpx_le_u32 vcc, s59, v25
    ds_write_b32 v78, v53 offset:4
    s_mov_b64 exec, -1
    v_and_b32 v80, -4, v26
    v_cmpx_le_u32 vcc, s59, v26
    ds_write_b32 v80, v54 offset:4
    s_mov_b64 exec, -1
    v_and_b32 v78, -4, v27
    v_cmpx_le_u32 vcc, s59, v27
    ds_write_b32 v78, v55 offset:4
    s_mov_b64 exec, -1
    v_and_b32 v81, 2, v24
    v_lshl_add_u32 v81, v81, 1, v24
    v_cmpx_le_u32 vcc, s59, v24
    ds_write_b16 v81, v72 offset:2
    s_mov_b64 exec, -1
    v_and_b32 v79, 2, v25
    v_lshl_add_u32 v79, v79, 1, v25
    v_cmpx_le_u32 vcc, s59, v25
    ds_write_b16_d16_hi v79, v72 offset:2
    s_mov_b64 exec, -1
    v_and_b32 v81, 2, v26
    v_lshl_add_u32 v81, v81, 1, v26
    v_cmpx_le_u32 vcc, s59, v26
    ds_write_b16 v81, v73 offset:2
    s_mov_b64 exec, -1
    v_and_b32 v79, 2, v27
    v_lshl_add_u32 v79, v79, 1, v27
    v_cmpx_le_u32 vcc, s59, v27
    ds_write_b16_d16_hi v79, v73 offset:2
    s_mov_b64 exec, -1
    v_and_b32 v80, -4, v28
    v_cmpx_le_u32 vcc, s59, v28
    ds_write_b32 v80, v56 offset:4
    s_mov_b64 exec, -1
    v_and_b32 v78, -4, v29
    v_cmpx_le_u32 vcc, s59, v29
    ds_write_b32 v78, v57 offset:4
    s_mov_b64 exec, -1
    v_and_b32 v80, -4, v30
    v_cmpx_le_u32 vcc, s59, v30
    ds_write_b32 v80, v58 offset:4
    s_mov_b64 exec, -1
    v_and_b32 v78, -4, v31
    v_cmpx_le_u32 vcc, s59, v31
    ds_write_b32 v78, v59 offset:4
    s_mov_b64 exec, -1
    v_and_b32 v81, 2, v28
    v_lshl_add_u32 v81, v81, 1, v28
    v_cmpx_le_u32 vcc, s59, v28
    ds_write_b16 v81, v74 offset:2
    s_mov_b64 exec, -1
    v_and_b32 v79, 2, v29
    v_lshl_add_u32 v79, v79, 1, v29
    v_cmpx_le_u32 vcc, s59, v29
    ds_write_b16_d16_hi v79, v74 offset:2
    s_mov_b64 exec, -1
    v_and_b32 v81, 2, v30
    v_lshl_add_u32 v81, v81, 1, v30
    v_cmpx_le_u32 vcc, s59, v30
    ds_write_b16 v81, v75 offset:2
    s_mov_b64 exec, -1
    v_and_b32 v79, 2, v31
    v_lshl_add_u32 v79, v79, 1, v31
    v_cmpx_le_u32 vcc, s59, v31
    ds_write_b16_d16_hi v79, v75 offset:2
    s_mov_b64 exec, -1
    s_waitcnt lgkmcnt(0)
    s_barrier
    ds_read_b128 v[24:27], v3 offset:0
    ds_read_b128 v[28:31], v3 offset:16384
    ds_read_b128 v[32:35], v3 offset:32768
    ds_read_b128 v[36:39], v3 offset:49152
    ds_read_b128 v[40:43], v4 offset:0
    s_waitcnt lgkmcnt(4)
    buffer_store_dwordx4 v[24:27], v1, s[24:27], s48 offen sc0 sc1
    s_waitcnt lgkmcnt(3)
    buffer_store_dwordx4 v[28:31], v1, s[24:27], s50 offen sc0 sc1
    s_waitcnt lgkmcnt(2)
    buffer_store_dwordx4 v[32:35], v1, s[24:27], s52 offen sc0 sc1
    s_waitcnt lgkmcnt(1)
    buffer_store_dwordx4 v[36:39], v1, s[24:27], s54 offen sc0 sc1
    s_waitcnt lgkmcnt(0)
    buffer_store_dwordx4 v[40:43], v1, s[24:27], s56 offen sc0 sc1
    s_cmp_ge_u32 s36, 3
    s_cbranch_scc1 K1_END
    ds_read_b128 v[44:47], v4 offset:16384
    s_waitcnt lgkmcnt(0)
    buffer_store_dwordx4 v[44:47], v5, s[24:27], 0 offen sc0 sc1
K1_END:
    s_endpgm
.globl gather_scatter__molecular_angular_gemnet__graph_kernel
.p2align 8
.type gather_scatter__molecular_angular_gemnet__graph_kernel,@function
gather_scatter__molecular_angular_gemnet__graph_kernel:
    s_cmp_ge_u32 s2, 256
    s_cbranch_scc1 K2_END
    s_load_dwordx2 s[12:13], s[0:1], 104
    s_load_dwordx2 s[8:9], s[0:1], 0
    s_load_dwordx2 s[16:17], s[0:1], 88
    s_load_dwordx2 s[20:21], s[0:1], 24
    s_load_dwordx2 s[92:93], s[0:1], 40
    s_load_dwordx8 s[80:87], s[0:1], 56
    s_and_b32 s3, s2, 7
    s_lshl_b32 s3, s3, 5
    s_lshr_b32 s38, s2, 3
    s_add_u32 s3, s3, s38
    s_mov_b32 s14, 44040192
    s_mov_b32 s15, 0x20000
    v_lshrrev_b32 v45, 2, v0
    v_lshlrev_b32 v46, 13, v45
    v_and_b32 v1, 3, v0
    s_lshl_b32 s38, s3, 5
    s_add_u32 s38, s38, 41943040
    v_lshl_add_u32 v46, v1, 3, v46
    v_add_u32 v46, s38, v46
    v_lshrrev_b32 v1, 6, v0
    v_and_b32 v65, 63, v0
    v_mov_b32 v66, v0
    v_readfirstlane_b32 s24, v1
    v_mov_b32 v4, 0
    v_mov_b32 v5, 0
    v_mov_b32 v6, 0
    v_mov_b32 v7, 0
    v_lshlrev_b32 v9, 4, v66
    v_add_u32 v8, 59968, v9
    v_add_u32 v10, 125504, v9
    s_waitcnt lgkmcnt(0)
    buffer_load_dwordx2 v[60:61], v46, s[12:15], 0 offen
    s_mov_b32 s39, 150016
    v_mul_u32_u24 v45, s39, v45
    v_and_b32 v44, 15, v65
    v_mul_u32_u24 v44, 12, v44
    s_mov_b32 s78, 0xfffefffe
    s_mov_b32 s79, 0xfffefffe
    v_mov_b32 v0, 59968
    v_mov_b32 v1, 111712
    v_cmp_gt_u32 vcc, 0x100, v66
    v_mov_b32 v64, 8
    v_mov_b32 v67, 0
    v_cndmask_b32 v0, v1, v0, vcc
    v_cmp_gt_u32 vcc, 0x200, v66
    v_lshlrev_b32 v1, 2, v66
    v_mov_b32 v47, 0x07070707
    v_cndmask_b32 v0, 0, v0, vcc
    v_cmp_gt_u32 vcc, 656, v66
    s_nop 0
    s_mov_b64 exec, vcc
    ds_write_b32 v1, v0
    s_mov_b64 exec, -1
    s_mov_b32 s31, 264
    s_mov_b32 s33, 0x02010000
    s_mul_i32 s34, s24, 352
    s_add_u32 s34, s34, 5184
    s_mov_b32 s29, 0
    s_mov_b32 s30, 0
    s_mov_b32 s26, 60224
    s_mov_b32 s72, 0
    s_waitcnt vmcnt(0)
    v_and_b32 v1, 3, v65
    v_mov_b32_dpp v0, v60 quad_perm:[0,0,0,0] row_mask:0xf bank_mask:0xf
    v_bfe_u32 v62, v0, 1, 15
    v_lshrrev_b32 v63, 16, v0
    v_add_u32 v1, v62, v1
    v_and_b32 v0, 0xffff, v0
    v_mad_u32_u24 v62, v1, 12, v45
    v_lshlrev_b32 v1, 1, v1
    v_sub_u32 v63, v63, v1
    v_cmp_ge_u32 s[66:67], v1, v0
    v_cmp_lt_i32 s[68:69], 32, v63
    v_mul_i32_i24 v63, 6, v63
    v_add_u32_dpp v1, v62, v44 row_newbcast:0 row_mask:0xf bank_mask:0xf
    s_nop 0
    v_sub_u32_dpp v0, v63, v44 row_newbcast:0 row_mask:0xf bank_mask:0xf
    s_lshr_b64 s[64:65], s[66:67], 0
    v_cmp_lt_i32 s[40:41], 0, v0
    v_cmp_lt_i32 s[42:43], 6, v0
    s_or_b64 s[64:65], s[64:65], s[78:79]
    v_cndmask_b32 v1, -1, v1, s[40:41]
    buffer_load_dwordx3 v[28:30], v1, s[12:15], 0 offen
    s_and_b64 s[40:41], s[40:41], s[64:65]
    v_add_u32_dpp v1, v62, v44 row_newbcast:4 row_mask:0xf bank_mask:0xf
    v_sub_u32_dpp v0, v63, v44 row_newbcast:4 row_mask:0xf bank_mask:0xf
    s_lshr_b64 s[64:65], s[66:67], 4
    v_cmp_lt_i32 s[44:45], 0, v0
    v_cmp_lt_i32 s[46:47], 6, v0
    s_or_b64 s[64:65], s[64:65], s[78:79]
    v_cndmask_b32 v1, -1, v1, s[44:45]
    buffer_load_dwordx3 v[32:34], v1, s[12:15], 0 offen
    s_and_b64 s[44:45], s[44:45], s[64:65]
    v_add_u32_dpp v1, v62, v44 row_newbcast:8 row_mask:0xf bank_mask:0xf
    v_sub_u32_dpp v0, v63, v44 row_newbcast:8 row_mask:0xf bank_mask:0xf
    s_lshr_b64 s[64:65], s[66:67], 8
    v_cmp_lt_i32 s[48:49], 0, v0
    v_cmp_lt_i32 s[50:51], 6, v0
    s_or_b64 s[64:65], s[64:65], s[78:79]
    v_cndmask_b32 v1, -1, v1, s[48:49]
    buffer_load_dwordx3 v[36:38], v1, s[12:15], 0 offen
    s_and_b64 s[48:49], s[48:49], s[64:65]
    v_add_u32_dpp v1, v62, v44 row_newbcast:12 row_mask:0xf bank_mask:0xf
    v_sub_u32_dpp v0, v63, v44 row_newbcast:12 row_mask:0xf bank_mask:0xf
    s_lshr_b64 s[64:65], s[66:67], 12
    v_cmp_lt_i32 s[52:53], 0, v0
    v_cmp_lt_i32 s[54:55], 6, v0
    s_or_b64 s[64:65], s[64:65], s[78:79]
    v_cndmask_b32 v1, -1, v1, s[52:53]
    buffer_load_dwordx3 v[40:42], v1, s[12:15], 0 offen
    s_and_b64 s[52:53], s[52:53], s[64:65]
    ds_write_b128 v8, v[4:7] offset:0
    ds_write_b128 v8, v[4:7] offset:16384
    ds_write_b128 v8, v[4:7] offset:32768
    ds_write_b128 v8, v[4:7] offset:49152
    s_waitcnt lgkmcnt(0)
    s_barrier
    s_setprio 3
    s_waitcnt vmcnt(3)
    s_setprio 3
    s_or_b64 s[64:65], s[40:41], s[42:43]
    s_cbranch_scc0 SK_2
    v_lshrrev_b32 v54, 24, v28
    v_lshl_add_u32 v55, v54, 2, s72
    v_lshrrev_b32 v58, 24, v30
    v_lshl_add_u32 v59, v58, 2, s72
    s_mov_b64 exec, s[40:41]
    ds_add_rtn_u32 v55, v55, v64
    s_mov_b64 exec, s[42:43]
    ds_add_rtn_u32 v59, v59, v64
    s_mov_b64 exec, -1
    v_lshlrev_b32 v52, 16, v29
    v_and_b32 v56, 0xffff0000, v29
    v_mul_f32 v52, 0.15915494, v52
    v_mul_f32 v56, 0.15915494, v56
    v_fract_f32 v52, v52
    v_fract_f32 v56, v56
    v_cos_f32 v52, v52
    v_cos_f32 v56, v56
    v_fma_f32 v0, v52, v52, -0.5
    v_fma_f32 v1, v56, v56, -0.5
    v_cvt_pk_bf16_f32 v52, v52, v0
    v_cvt_pk_bf16_f32 v56, v56, v1
    v_perm_b32 v53, v28, v28, s33
    v_perm_b32 v57, v30, v30, s33
    s_waitcnt lgkmcnt(0)
    s_mov_b64 exec, s[40:41]
    v_cmp_gt_u32 vcc, s26, v55
    v_mad_u32_u24 v55, v54, s31, v55
    s_andn2_b64 s[62:63], s[40:41], vcc
    s_cbranch_scc1 RARE_3
BACK_4:
    s_mov_b64 exec, vcc
    ds_write_b64 v55, v[52:53]
    s_mov_b64 exec, s[42:43]
    v_cmp_gt_u32 vcc, s26, v59
    v_mad_u32_u24 v59, v58, s31, v59
    s_andn2_b64 s[62:63], s[42:43], vcc
    s_cbranch_scc1 RARE_5
BACK_6:
    s_mov_b64 exec, vcc
    ds_write_b64 v59, v[56:57]
    s_mov_b64 exec, -1
SK_2:
    s_cmp_lg_u64 s[68:69], 0
    s_cbranch_scc1 LONG_7
LBACK_8:
    v_and_b32 v1, 3, v65
    v_mov_b32_dpp v0, v60 quad_perm:[1,1,1,1] row_mask:0xf bank_mask:0xf
    v_bfe_u32 v62, v0, 1, 15
    v_lshrrev_b32 v63, 16, v0
    v_add_u32 v1, v62, v1
    v_and_b32 v0, 0xffff, v0
    v_mad_u32_u24 v62, v1, 12, v45
    v_lshlrev_b32 v1, 1, v1
    v_sub_u32 v63, v63, v1
    v_cmp_ge_u32 s[66:67], v1, v0
    v_cmp_lt_i32 s[68:69], 32, v63
    v_mul_i32_i24 v63, 6, v63
    v_add_u32_dpp v1, v62, v44 row_newbcast:0 row_mask:0xf bank_mask:0xf
    s_nop 0
    v_sub_u32_dpp v0, v63, v44 row_newbcast:0 row_mask:0xf bank_mask:0xf
    s_lshr_b64 s[64:65], s[66:67], 0
    v_cmp_lt_i32 s[40:41], 0, v0
    v_cmp_lt_i32 s[42:43], 6, v0
    s_or_b64 s[64:65], s[64:65], s[78:79]
    v_cndmask_b32 v1, -1, v1, s[40:41]
    buffer_load_dwordx3 v[28:30], v1, s[12:15], 0 offen
    s_and_b64 s[40:41], s[40:41], s[64:65]
    s_waitcnt vmcnt(3)
    s_setprio 3
    s_or_b64 s[64:65], s[44:45], s[46:47]
    s_cbranch_scc0 SK_9
    v_lshrrev_b32 v54, 24, v32
    v_lshl_add_u32 v55, v54, 2, s72
    v_lshrrev_b32 v58, 24, v34
    v_lshl_add_u32 v59, v58, 2, s72
    s_mov_b64 exec, s[44:45]
    ds_add_rtn_u32 v55, v55, v64
    s_mov_b64 exec, s[46:47]
    ds_add_rtn_u32 v59, v59, v64
    s_mov_b64 exec, -1
    v_lshlrev_b32 v52, 16, v33
    v_and_b32 v56, 0xffff0000, v33
    v_mul_f32 v52, 0.15915494, v52
    v_mul_f32 v56, 0.15915494, v56
    v_fract_f32 v52, v52
    v_fract_f32 v56, v56
    v_cos_f32 v52, v52
    v_cos_f32 v56, v56
    v_fma_f32 v0, v52, v52, -0.5
    v_fma_f32 v1, v56, v56, -0.5
    v_cvt_pk_bf16_f32 v52, v52, v0
    v_cvt_pk_bf16_f32 v56, v56, v1
    v_perm_b32 v53, v32, v32, s33
    v_perm_b32 v57, v34, v34, s33
    s_waitcnt lgkmcnt(0)
    s_mov_b64 exec, s[44:45]
    v_cmp_gt_u32 vcc, s26, v55
    v_mad_u32_u24 v55, v54, s31, v55
    s_andn2_b64 s[62:63], s[44:45], vcc
    s_cbranch_scc1 RARE_10
BACK_11:
    s_mov_b64 exec, vcc
    ds_write_b64 v55, v[52:53]
    s_mov_b64 exec, s[46:47]
    v_cmp_gt_u32 vcc, s26, v59
    v_mad_u32_u24 v59, v58, s31, v59
    s_andn2_b64 s[62:63], s[46:47], vcc
    s_cbranch_scc1 RARE_12
BACK_13:
    s_mov_b64 exec, vcc
    ds_write_b64 v59, v[56:57]
    s_mov_b64 exec, -1
SK_9:
    v_add_u32_dpp v1, v62, v44 row_newbcast:4 row_mask:0xf bank_mask:0xf
    v_sub_u32_dpp v0, v63, v44 row_newbcast:4 row_mask:0xf bank_mask:0xf
    s_lshr_b64 s[64:65], s[66:67], 4
    v_cmp_lt_i32 s[44:45], 0, v0
    v_cmp_lt_i32 s[46:47], 6, v0
    s_or_b64 s[64:65], s[64:65], s[78:79]
    v_cndmask_b32 v1, -1, v1, s[44:45]
    buffer_load_dwordx3 v[32:34], v1, s[12:15], 0 offen
    s_and_b64 s[44:45], s[44:45], s[64:65]
    s_waitcnt vmcnt(3)
    s_setprio 2
    s_or_b64 s[64:65], s[48:49], s[50:51]
    s_cbranch_scc0 SK_14
    v_lshrrev_b32 v54, 24, v36
    v_lshl_add_u32 v55, v54, 2, s72
    v_lshrrev_b32 v58, 24, v38
    v_lshl_add_u32 v59, v58, 2, s72
    s_mov_b64 exec, s[48:49]
    ds_add_rtn_u32 v55, v55, v64
    s_mov_b64 exec, s[50:51]
    ds_add_rtn_u32 v59, v59, v64
    s_mov_b64 exec, -1
    v_lshlrev_b32 v52, 16, v37
    v_and_b32 v56, 0xffff0000, v37
    v_mul_f32 v52, 0.15915494, v52
    v_mul_f32 v56, 0.15915494, v56
    v_fract_f32 v52, v52
    v_fract_f32 v56, v56
    v_cos_f32 v52, v52
    v_cos_f32 v56, v56
    v_fma_f32 v0, v52, v52, -0.5
    v_fma_f32 v1, v56, v56, -0.5
    v_cvt_pk_bf16_f32 v52, v52, v0
    v_cvt_pk_bf16_f32 v56, v56, v1
    v_perm_b32 v53, v36, v36, s33
    v_perm_b32 v57, v38, v38, s33
    s_waitcnt lgkmcnt(0)
    s_mov_b64 exec, s[48:49]
    v_cmp_gt_u32 vcc, s26, v55
    v_mad_u32_u24 v55, v54, s31, v55
    s_andn2_b64 s[62:63], s[48:49], vcc
    s_cbranch_scc1 RARE_15
BACK_16:
    s_mov_b64 exec, vcc
    ds_write_b64 v55, v[52:53]
    s_mov_b64 exec, s[50:51]
    v_cmp_gt_u32 vcc, s26, v59
    v_mad_u32_u24 v59, v58, s31, v59
    s_andn2_b64 s[62:63], s[50:51], vcc
    s_cbranch_scc1 RARE_17
BACK_18:
    s_mov_b64 exec, vcc
    ds_write_b64 v59, v[56:57]
    s_mov_b64 exec, -1
SK_14:
    v_add_u32_dpp v1, v62, v44 row_newbcast:8 row_mask:0xf bank_mask:0xf
    v_sub_u32_dpp v0, v63, v44 row_newbcast:8 row_mask:0xf bank_mask:0xf
    s_lshr_b64 s[64:65], s[66:67], 8
    v_cmp_lt_i32 s[48:49], 0, v0
    v_cmp_lt_i32 s[50:51], 6, v0
    s_or_b64 s[64:65], s[64:65], s[78:79]
    v_cndmask_b32 v1, -1, v1, s[48:49]
    buffer_load_dwordx3 v[36:38], v1, s[12:15], 0 offen
    s_and_b64 s[48:49], s[48:49], s[64:65]
    s_waitcnt vmcnt(3)
    s_setprio 1
    s_or_b64 s[64:65], s[52:53], s[54:55]
    s_cbranch_scc0 SK_19
    v_lshrrev_b32 v54, 24, v40
    v_lshl_add_u32 v55, v54, 2, s72
    v_lshrrev_b32 v58, 24, v42
    v_lshl_add_u32 v59, v58, 2, s72
    s_mov_b64 exec, s[52:53]
    ds_add_rtn_u32 v55, v55, v64
    s_mov_b64 exec, s[54:55]
    ds_add_rtn_u32 v59, v59, v64
    s_mov_b64 exec, -1
    v_lshlrev_b32 v52, 16, v41
    v_and_b32 v56, 0xffff0000, v41
    v_mul_f32 v52, 0.15915494, v52
    v_mul_f32 v56, 0.15915494, v56
    v_fract_f32 v52, v52
    v_fract_f32 v56, v56
    v_cos_f32 v52, v52
    v_cos_f32 v56, v56
    v_fma_f32 v0, v52, v52, -0.5
    v_fma_f32 v1, v56, v56, -0.5
    v_cvt_pk_bf16_f32 v52, v52, v0
    v_cvt_pk_bf16_f32 v56, v56, v1
    v_perm_b32 v53, v40, v40, s33
    v_perm_b32 v57, v42, v42, s33
    s_waitcnt lgkmcnt(0)
    s_mov_b64 exec, s[52:53]
    v_cmp_gt_u32 vcc, s26, v55
    v_mad_u32_u24 v55, v54, s31, v55
    s_andn2_b64 s[62:63], s[52:53], vcc
    s_cbranch_scc1 RARE_20
BACK_21:
    s_mov_b64 exec, vcc
    ds_write_b64 v55, v[52:53]
    s_mov_b64 exec, s[54:55]
    v_cmp_gt_u32 vcc, s26, v59
    v_mad_u32_u24 v59, v58, s31, v59
    s_andn2_b64 s[62:63], s[54:55], vcc
    s_cbranch_scc1 RARE_22
BACK_23:
    s_mov_b64 exec, vcc
    ds_write_b64 v59, v[56:57]
    s_mov_b64 exec, -1
SK_19:
    s_mov_b64 exec, 1
    ds_add_u32 v67, v64 offset:2068
    s_mov_b64 exec, -1
    s_setprio 0
    v_add_u32_dpp v1, v62, v44 row_newbcast:12 row_mask:0xf bank_mask:0xf
    v_sub_u32_dpp v0, v63, v44 row_newbcast:12 row_mask:0xf bank_mask:0xf
    s_lshr_b64 s[64:65], s[66:67], 12
    v_cmp_lt_i32 s[52:53], 0, v0
    v_cmp_lt_i32 s[54:55], 6, v0
    s_or_b64 s[64:65], s[64:65], s[78:79]
    v_cndmask_b32 v1, -1, v1, s[52:53]
    buffer_load_dwordx3 v[40:42], v1, s[12:15], 0 offen
    s_and_b64 s[52:53], s[52:53], s[64:65]
    s_load_dwordx4 s[88:91], s[92:93], 0
    ds_write_b128 v10, v[4:7] offset:0
    ds_write_b128 v10, v[4:7] offset:16384
    ds_write_b128 v10, v[4:7] offset:32768
    v_mov_b32 v76, 0
    v_mov_b32 v77, 0
    v_mov_b32 v78, 0
    v_mov_b32 v79, 0
    v_mov_b32 v80, 0
    v_mov_b32 v81, 0
    v_mov_b32 v82, 0
    v_mov_b32 v83, 0
    v_mov_b32 v84, 0
    v_mov_b32 v85, 0
    v_mov_b32 v86, 0
    v_mov_b32 v87, 0
    v_mov_b32 v88, 0
    v_mov_b32 v89, 0
    v_mov_b32 v90, 0
    v_mov_b32 v91, 0
    v_mov_b32 v92, 0
    v_mov_b32 v93, 0
    v_mov_b32 v94, 0
    v_mov_b32 v95, 0
    v_mov_b32 v96, 0
    v_mov_b32 v97, 0
    v_mov_b32 v98, 0
    v_mov_b32 v99, 0
    v_mov_b32 v100, 0
    v_mov_b32 v101, 0
    v_mov_b32 v102, 0
    v_mov_b32 v103, 0
    v_mov_b32 v104, 0
    v_mov_b32 v105, 0
    v_mov_b32 v106, 0
    v_mov_b32 v107, 0
    v_mov_b32 v108, 0
    v_mov_b32 v109, 0
    v_mov_b32 v110, 0
    v_mov_b32 v111, 0
    v_mov_b32 v112, 0
    v_mov_b32 v113, 0
    v_mov_b32 v114, 0
    v_mov_b32 v115, 0
    v_mov_b32 v116, 0
    v_mov_b32 v117, 0
    v_mov_b32 v118, 0
    v_mov_b32 v119, 0
    v_mov_b32 v120, 0
    v_mov_b32 v121, 0
    v_mov_b32 v122, 0
    v_mov_b32 v123, 0
    v_mov_b32 v124, 0
    v_mov_b32 v125, 0
    v_mov_b32 v126, 0
    v_mov_b32 v127, 0
    s_mov_b32 s10, 12800000
    s_mov_b32 s11, 0x20000
    s_mov_b32 s18, 12800000
    s_mov_b32 s19, 0x20000
    s_mov_b32 s22, 800000
    s_mov_b32 s23, 0x20000
    s_lshl_b32 s25, s24, 2
    s_cmp_lt_u32 s24, 4
    s_cselect_b32 s36, 13, 12
    s_mov_b32 s32, 0x00ffffe0
    s_mov_b32 s28, 0
    v_lshrrev_b32 v0, 1, v65
    v_add_u32 v0, 1, v0
    v_lshlrev_b32 v0, 5, v0
    v_and_b32 v1, 1, v65
    v_lshlrev_b32 v1, 4, v1
    v_sub_u32 v31, v0, v1
    v_bfe_u32 v0, v65, 1, 3
    v_lshlrev_b32 v0, 3, v0
    v_mov_b32 v2, 0xff
    v_mov_b32 v3, 0
    v_lshlrev_b64 v[2:3], v0, v[2:3]
    s_mul_i32 s74, s24, 3072
    s_add_u32 s74, s74, 10816
    s_add_u32 s75, s74, 1024
    s_add_u32 s76, s74, 2048
    v_lshl_add_u32 v48, v65, 3, s74
    v_add_u32 v49, 1024, v48
    v_add_u32 v50, 2048, v48
    s_mul_i32 s38, s24, 264
    s_add_u32 s38, s38, 59968
    v_lshrrev_b32 v0, 2, v65
    v_lshl_add_u32 v39, v0, 3, s38
    v_lshrrev_b32 v0, 1, v65
    v_lshl_add_u32 v35, v0, 3, s38
    s_mov_b64 exec, 1
    ds_add_u32 v67, v64 offset:2064
    s_mov_b64 exec, -1
    s_mul_i32 s38, s3, 3136
    s_lshl_b32 s39, s24, 4
    s_add_u32 s38, s38, s39
    v_lshrrev_b32 v0, 2, v65
    v_and_b32 v1, 3, v65
    v_lshlrev_b32 v0, 8, v0
    v_lshl_add_u32 v0, v1, 2, v0
    v_add_u32 v0, s38, v0
    buffer_load_dword v75, v0, s[20:23], 0 offen
    s_cmp_gt_u32 s24, 4
    s_cbranch_scc1 NOST_24
    s_cmp_lt_u32 s24, 2
    s_cselect_b32 s96, s82, s80
    s_cselect_b32 s97, s83, s81
    s_cselect_b32 s39, 64, 32
    s_cmp_eq_u32 s24, 3
    s_cselect_b32 s96, s84, s96
    s_cselect_b32 s97, s85, s97
    s_cmp_eq_u32 s24, 4
    s_cselect_b32 s96, s86, s96
    s_cselect_b32 s97, s87, s97
    s_cmp_eq_u32 s24, 2
    s_cselect_b32 s98, 1, 2
    s_lshl_b32 s98, s98, 8
    s_mov_b32 s99, 0x20000
    s_cmp_lt_u32 s24, 3
    s_cselect_b32 s38, 1, 3
    s_cmp_eq_u32 s24, 1
    s_cselect_b32 s70, 32, 0
    v_lshrrev_b32 v1, 4, v65
    v_and_b32 v1, s38, v1
    v_lshlrev_b32 v1, 2, v1
    v_and_b32 v0, 15, v65
    v_lshlrev_b32 v0, 1, v0
    v_mad_u32_u24 v1, v1, s39, v0
    v_add_u32 v1, s70, v1
    buffer_load_ushort v20, v1, s[96:99], 0 offen
    v_add_u32 v1, s39, v1
    buffer_load_ushort v21, v1, s[96:99], 0 offen
    v_add_u32 v1, s39, v1
    buffer_load_ushort v22, v1, s[96:99], 0 offen
    v_add_u32 v1, s39, v1
    buffer_load_ushort v23, v1, s[96:99], 0 offen
    s_nop 0
NOST_24:
    s_mov_b32 s26, 111968
    s_mov_b32 s73, 59968
    s_mov_b32 s27, 51744
    s_mov_b32 s7, 128
    s_mov_b32 s4, 128
    s_mov_b32 s5, 0
K2_LOOP:
    s_cmp_lt_u32 s5, s7
    s_cbranch_scc1 POLL_25
PDONE_26:
    s_setprio 3
    v_and_b32 v0, 15, v65
    s_add_u32 s38, s72, s25
    v_lshl_add_u32 v66, v0, 6, s38
    ds_read_b32 v43, v66 offset:0
    ds_read_b32 v54, v67 offset:2048
    s_xor_b32 s72, s72, 1024
    ds_read_b32 v51, v35 offset:50692
    ds_read_b64_tr_b16 v[24:25], v39 offset:50688
    ds_read_b64_tr_b16 v[26:27], v39 offset:50816
    s_cmp_lg_u32 s28, 0
    s_cbranch_scc0 SK_27
    s_waitcnt vmcnt(2)
    ds_read_b64_tr_b16 v[20:21], v48
    ds_read_b64_tr_b16 v[22:23], v48 offset:512
SK_27:
    s_waitcnt lgkmcnt(0)
    v_readfirstlane_b32 s35, v54
    s_nop 0
    s_mov_b32 s71, s35
    s_cmp_gt_u32 s71, 32
    s_cselect_b32 s35, 1, 0
    s_cmp_gt_u32 s71, 0xffff
    s_cselect_b32 s35, 0x100, s35
    s_cmp_eq_u32 s28, 5
    s_cselect_b32 s77, s35, 1
    v_cmp_gt_u32 vcc, s36, v0
    v_subrev_u32 v43, s73, v43
    v_mov_b32 v1, s73
    v_min_u32 v43, 0x100, v43
    v_lshlrev_b32 v43, 2, v43
    v_cndmask_b32 v43, 0, v43, vcc
    s_and_b64 exec, vcc, 0xffff
    ds_write_b32 v66, v1 offset:0
    s_mov_b64 exec, -1
    s_cmp_lg_u32 s28, 0
    s_cbranch_scc0 SK_28
    v_mfma_f32_16x16x32_bf16 v[84:87], v[20:23], v[8:11], v[84:87]
SK_28:
    s_mov_b32 m0, s74
    v_lshrrev_b32 v51, 8, v51
    v_sub_u32_dpp v1, v43, v31 row_newbcast:12 row_mask:0xf bank_mask:0xf
    v_bfi_b32 v51, s32, v51, v1
    buffer_load_dwordx4 v51, s[8:11], 0 offen  lds
    v_and_b32_dpp v4, v24, v47 quad_perm:[2,2,2,2] row_mask:0xf bank_mask:0xf
    v_and_b32_dpp v5, v25, v47 quad_perm:[2,2,2,2] row_mask:0xf bank_mask:0xf
    v_and_b32_dpp v6, v26, v47 quad_perm:[2,2,2,2] row_mask:0xf bank_mask:0xf
    v_and_b32_dpp v7, v27, v47 quad_perm:[2,2,2,2] row_mask:0xf bank_mask:0xf
    v_perm_b32 v4, v3, v2, v4
    v_perm_b32 v5, v3, v2, v5
    v_perm_b32 v6, v3, v2, v6
    v_perm_b32 v7, v3, v2, v7
    v_and_b32_dpp v4, v24, v4 quad_perm:[0,1,0,1] row_mask:0xf bank_mask:0xf
    v_and_b32_dpp v5, v25, v5 quad_perm:[0,1,0,1] row_mask:0xf bank_mask:0xf
    v_and_b32_dpp v6, v26, v6 quad_perm:[0,1,0,1] row_mask:0xf bank_mask:0xf
    v_and_b32_dpp v7, v27, v7 quad_perm:[0,1,0,1] row_mask:0xf bank_mask:0xf
    ds_read_b32 v51, v35 offset:46468
    ds_read_b64_tr_b16 v[24:25], v39 offset:46464
    ds_read_b64_tr_b16 v[26:27], v39 offset:46592
    s_cmp_lg_u32 s28, 0
    s_cbranch_scc0 SK_29
    s_waitcnt vmcnt(2)
    ds_read_b64_tr_b16 v[20:21], v49
    ds_read_b64_tr_b16 v[22:23], v49 offset:512
SK_29:
    s_waitcnt lgkmcnt(0)
    s_cmp_lg_u32 s28, 0
    s_cbranch_scc0 SK_30
    v_mfma_f32_16x16x32_bf16 v[80:83], v[20:23], v[12:15], v[80:83]
SK_30:
    s_mov_b32 m0, s75
    v_lshrrev_b32 v51, 8, v51
    v_sub_u32_dpp v1, v43, v31 row_newbcast:11 row_mask:0xf bank_mask:0xf
    v_bfi_b32 v51, s32, v51, v1
    buffer_load_dwordx4 v51, s[8:11], 0 offen  lds
    v_and_b32_dpp v8, v24, v47 quad_perm:[2,2,2,2] row_mask:0xf bank_mask:0xf
    v_and_b32_dpp v9, v25, v47 quad_perm:[2,2,2,2] row_mask:0xf bank_mask:0xf
    v_and_b32_dpp v10, v26, v47 quad_perm:[2,2,2,2] row_mask:0xf bank_mask:0xf
    v_and_b32_dpp v11, v27, v47 quad_perm:[2,2,2,2] row_mask:0xf bank_mask:0xf
    v_perm_b32 v8, v3, v2, v8
    v_perm_b32 v9, v3, v2, v9
    v_perm_b32 v10, v3, v2, v10
    v_perm_b32 v11, v3, v2, v11
    v_and_b32_dpp v8, v24, v8 quad_perm:[0,1,0,1] row_mask:0xf bank_mask:0xf
    v_and_b32_dpp v9, v25, v9 quad_perm:[0,1,0,1] row_mask:0xf bank_mask:0xf
    v_and_b32_dpp v10, v26, v10 quad_perm:[0,1,0,1] row_mask:0xf bank_mask:0xf
    v_and_b32_dpp v11, v27, v11 quad_perm:[0,1,0,1] row_mask:0xf bank_mask:0xf
    s_cmp_eq_u32 s28, 1
    s_cbranch_scc1 SD_31
SDE_32:
    s_cmp_eq_u32 s28, 2
    s_cbranch_scc1 SD_33
SDE_34:
    ds_read_b32 v51, v35 offset:42244
    ds_read_b64_tr_b16 v[24:25], v39 offset:42240
    ds_read_b64_tr_b16 v[26:27], v39 offset:42368
    ds_read_b32 v46, v67 offset:2064
    v_lshl_add_u32 v0, v65, 3, s34
    s_cmp_eq_u32 s28, 5
    s_cselect_b32 s38, 0, s29
    ds_read_b32 v54, v0
    ds_read_b32 v56, v0 offset:4
    v_cmp_gt_u32 s[60:61], s38, v65
    s_sub_u32 s29, s29, s38
    s_cmp_lg_u32 s28, 0
    s_cbranch_scc0 SK_35
    s_waitcnt vmcnt(2)
    ds_read_b64_tr_b16 v[20:21], v50
    ds_read_b64_tr_b16 v[22:23], v50 offset:512
SK_35:
    s_waitcnt lgkmcnt(0)
    v_readfirstlane_b32 s5, v46
    s_cmp_lg_u32 s28, 0
    s_cbranch_scc0 SK_36
    v_mfma_f32_16x16x32_bf16 v[76:79], v[20:23], v[16:19], v[76:79]
SK_36:
    s_mov_b32 m0, s76
    v_lshrrev_b32 v51, 8, v51
    v_sub_u32_dpp v1, v43, v31 row_newbcast:10 row_mask:0xf bank_mask:0xf
    v_bfi_b32 v51, s32, v51, v1
    buffer_load_dwordx4 v51, s[8:11], 0 offen  lds
    v_and_b32_dpp v12, v24, v47 quad_perm:[2,2,2,2] row_mask:0xf bank_mask:0xf
    v_and_b32_dpp v13, v25, v47 quad_perm:[2,2,2,2] row_mask:0xf bank_mask:0xf
    v_and_b32_dpp v14, v26, v47 quad_perm:[2,2,2,2] row_mask:0xf bank_mask:0xf
    v_and_b32_dpp v15, v27, v47 quad_perm:[2,2,2,2] row_mask:0xf bank_mask:0xf
    v_perm_b32 v12, v3, v2, v12
    v_perm_b32 v13, v3, v2, v13
    v_perm_b32 v14, v3, v2, v14
    v_perm_b32 v15, v3, v2, v15
    v_and_b32_dpp v12, v24, v12 quad_perm:[0,1,0,1] row_mask:0xf bank_mask:0xf
    v_and_b32_dpp v13, v25, v13 quad_perm:[0,1,0,1] row_mask:0xf bank_mask:0xf
    v_and_b32_dpp v14, v26, v14 quad_perm:[0,1,0,1] row_mask:0xf bank_mask:0xf
    v_and_b32_dpp v15, v27, v15 quad_perm:[0,1,0,1] row_mask:0xf bank_mask:0xf
    s_setprio 2
    ds_read_b32 v51, v35 offset:38020
    ds_read_b64_tr_b16 v[24:25], v39 offset:38016
    ds_read_b64_tr_b16 v[26:27], v39 offset:38144
    s_cmp_lt_u32 s5, s4
    s_cbranch_scc1 POLL_37
PDONE_38:
    s_cmp_lg_u64 s[60:61], 0
    s_cbranch_scc0 SK_39
    v_lshrrev_b32 v58, 24, v54
    v_lshl_add_u32 v59, v58, 2, s72
    s_mov_b64 exec, s[60:61]
    ds_add_rtn_u32 v59, v59, v64
    s_mov_b64 exec, -1
    v_perm_b32 v57, v54, v54, s33
SK_39:
    s_waitcnt vmcnt(2)
    s_cmp_eq_u32 s28, 0
    s_cbranch_scc1 SD_40
SDE_41:
    ds_read_b64_tr_b16 v[20:21], v48
    ds_read_b64_tr_b16 v[22:23], v48 offset:512
    s_waitcnt lgkmcnt(0)
    v_mfma_f32_16x16x32_bf16 v[124:127], v[20:23], v[4:7], v[124:127]
    s_cmp_eq_u32 s77, 0
    s_cbranch_scc1 SD_42
SDE_43:
    s_mov_b32 m0, s74
    v_lshrrev_b32 v51, 8, v51
    v_sub_u32_dpp v1, v43, v31 row_newbcast:9 row_mask:0xf bank_mask:0xf
    v_bfi_b32 v51, s32, v51, v1
    buffer_load_dwordx4 v51, s[8:11], 0 offen  lds
    v_and_b32_dpp v4, v24, v47 quad_perm:[2,2,2,2] row_mask:0xf bank_mask:0xf
    v_and_b32_dpp v5, v25, v47 quad_perm:[2,2,2,2] row_mask:0xf bank_mask:0xf
    v_and_b32_dpp v6, v26, v47 quad_perm:[2,2,2,2] row_mask:0xf bank_mask:0xf
    v_and_b32_dpp v7, v27, v47 quad_perm:[2,2,2,2] row_mask:0xf bank_mask:0xf
    v_perm_b32 v4, v3, v2, v4
    v_perm_b32 v5, v3, v2, v5
    v_perm_b32 v6, v3, v2, v6
    v_perm_b32 v7, v3, v2, v7
    v_and_b32_dpp v4, v24, v4 quad_perm:[0,1,0,1] row_mask:0xf bank_mask:0xf
    v_and_b32_dpp v5, v25, v5 quad_perm:[0,1,0,1] row_mask:0xf bank_mask:0xf
    v_and_b32_dpp v6, v26, v6 quad_perm:[0,1,0,1] row_mask:0xf bank_mask:0xf
    v_and_b32_dpp v7, v27, v7 quad_perm:[0,1,0,1] row_mask:0xf bank_mask:0xf
    s_cmp_lg_u64 s[60:61], 0
    s_cbranch_scc0 SK_44
    s_mov_b64 exec, s[60:61]
    v_cmp_gt_u32 vcc, s26, v59
    v_mad_u32_u24 v59, v58, s31, v59
    s_andn2_b64 s[62:63], s[60:61], vcc
    s_cbranch_scc1 RARE_45
BACK_46:
    s_mov_b64 exec, vcc
    ds_write_b64 v59, v[56:57]
    s_mov_b64 exec, -1
SK_44:
    ds_read_b32 v51, v35 offset:33796
    ds_read_b64_tr_b16 v[24:25], v39 offset:33792
    ds_read_b64_tr_b16 v[26:27], v39 offset:33920
    s_or_b64 s[64:65], s[40:41], s[42:43]
    s_cbranch_scc0 SK_47
    v_lshrrev_b32 v54, 24, v28
    v_lshl_add_u32 v55, v54, 2, s72
    v_lshrrev_b32 v58, 24, v30
    v_lshl_add_u32 v59, v58, 2, s72
    s_mov_b64 exec, s[40:41]
    ds_add_rtn_u32 v55, v55, v64
    s_mov_b64 exec, s[42:43]
    ds_add_rtn_u32 v59, v59, v64
    s_mov_b64 exec, -1
    v_lshlrev_b32 v52, 16, v29
    v_and_b32 v56, 0xffff0000, v29
    v_mul_f32 v52, 0.15915494, v52
    v_mul_f32 v56, 0.15915494, v56
    v_fract_f32 v52, v52
    v_fract_f32 v56, v56
    v_cos_f32 v52, v52
    v_cos_f32 v56, v56
    v_fma_f32 v0, v52, v52, -0.5
    v_fma_f32 v1, v56, v56, -0.5
    v_cvt_pk_bf16_f32 v52, v52, v0
    v_cvt_pk_bf16_f32 v56, v56, v1
    v_perm_b32 v53, v28, v28, s33
    v_perm_b32 v57, v30, v30, s33
SK_47:
    s_waitcnt vmcnt(2)
    ds_read_b64_tr_b16 v[20:21], v49
    ds_read_b64_tr_b16 v[22:23], v49 offset:512
    s_waitcnt lgkmcnt(0)
    v_mfma_f32_16x16x32_bf16 v[120:123], v[20:23], v[8:11], v[120:123]
    s_mov_b32 m0, s75
    v_lshrrev_b32 v51, 8, v51
    v_sub_u32_dpp v1, v43, v31 row_newbcast:8 row_mask:0xf bank_mask:0xf
    v_bfi_b32 v51, s32, v51, v1
    buffer_load_dwordx4 v51, s[8:11], 0 offen  lds
    v_and_b32_dpp v8, v24, v47 quad_perm:[2,2,2,2] row_mask:0xf bank_mask:0xf
    v_and_b32_dpp v9, v25, v47 quad_perm:[2,2,2,2] row_mask:0xf bank_mask:0xf
    v_and_b32_dpp v10, v26, v47 quad_perm:[2,2,2,2] row_mask:0xf bank_mask:0xf
    v_and_b32_dpp v11, v27, v47 quad_perm:[2,2,2,2] row_mask:0xf bank_mask:0xf
    v_perm_b32 v8, v3, v2, v8
    v_perm_b32 v9, v3, v2, v9
    v_perm_b32 v10, v3, v2, v10
    v_perm_b32 v11, v3, v2, v11
    v_and_b32_dpp v8, v24, v8 quad_perm:[0,1,0,1] row_mask:0xf bank_mask:0xf
    v_and_b32_dpp v9, v25, v9 quad_perm:[0,1,0,1] row_mask:0xf bank_mask:0xf
    v_and_b32_dpp v10, v26, v10 quad_perm:[0,1,0,1] row_mask:0xf bank_mask:0xf
    v_and_b32_dpp v11, v27, v11 quad_perm:[0,1,0,1] row_mask:0xf bank_mask:0xf
    s_or_b64 s[64:65], s[40:41], s[42:43]
    s_cbranch_scc0 SK_48
    s_mov_b64 exec, s[40:41]
    v_cmp_gt_u32 vcc, s26, v55
    v_mad_u32_u24 v55, v54, s31, v55
    s_andn2_b64 s[62:63], s[40:41], vcc
    s_cbranch_scc1 RARE_49
BACK_50:
    s_mov_b64 exec, vcc
    ds_write_b64 v55, v[52:53]
    s_mov_b64 exec, s[42:43]
    v_cmp_gt_u32 vcc, s26, v59
    v_mad_u32_u24 v59, v58, s31, v59
    s_andn2_b64 s[62:63], s[42:43], vcc
    s_cbranch_scc1 RARE_51
BACK_52:
    s_mov_b64 exec, vcc
    ds_write_b64 v59, v[56:57]
    s_mov_b64 exec, -1
SK_48:
    s_cmp_lg_u64 s[68:69], 0
    s_cbranch_scc1 LONG_53
LBACK_54:
    s_cmp_eq_u32 s28, 5
    s_cbranch_scc1 SD_55
    s_add_u32 s37, s28, 2
    v_and_b32 v1, 3, v65
    s_sub_u32 s38, s37, 4
    v_cmp_eq_u32 vcc, s37, v1
    v_cmp_eq_u32 s[66:67], s38, v1
    s_nop 0
    v_cndmask_b32 v0, 0, v60, vcc
    v_cndmask_b32 v0, v0, v61, s[66:67]
    s_nop 1
    v_or_b32_dpp v0, v0, v0 quad_perm:[1,0,3,2] row_mask:0xf bank_mask:0xf
    s_nop 1
    v_or_b32_dpp v0, v0, v0 quad_perm:[2,3,0,1] row_mask:0xf bank_mask:0xf
    v_bfe_u32 v62, v0, 1, 15
    v_lshrrev_b32 v63, 16, v0
    v_add_u32 v1, v62, v1
    v_and_b32 v0, 0xffff, v0
    v_mad_u32_u24 v62, v1, 12, v45
    v_lshlrev_b32 v1, 1, v1
    v_sub_u32 v63, v63, v1
    v_cmp_ge_u32 s[66:67], v1, v0
    v_cmp_lt_i32 s[68:69], 32, v63
    v_mul_i32_i24 v63, 6, v63
    v_add_u32_dpp v1, v62, v44 row_newbcast:0 row_mask:0xf bank_mask:0xf
    s_nop 0
    v_sub_u32_dpp v0, v63, v44 row_newbcast:0 row_mask:0xf bank_mask:0xf
    s_lshr_b64 s[64:65], s[66:67], 0
    v_cmp_lt_i32 s[40:41], 0, v0
    v_cmp_lt_i32 s[42:43], 6, v0
    s_or_b64 s[64:65], s[64:65], s[78:79]
    v_cndmask_b32 v1, -1, v1, s[40:41]
    buffer_load_dwordx3 v[28:30], v1, s[12:15], 0 offen
    s_and_b64 s[40:41], s[40:41], s[64:65]
SDE_56:
    s_cmp_eq_u32 s77, 0
    s_cselect_b32 s38, s71, 0
    s_cmp_lg_u32 s38, 0
    s_cbranch_scc1 SD_57
SDE_58:
    ds_read_b32 v51, v35 offset:29572
    ds_read_b64_tr_b16 v[24:25], v39 offset:29568
    ds_read_b64_tr_b16 v[26:27], v39 offset:29696
    s_or_b64 s[64:65], s[44:45], s[46:47]
    s_cbranch_scc0 SK_59
    v_lshrrev_b32 v54, 24, v32
    v_lshl_add_u32 v55, v54, 2, s72
    v_lshrrev_b32 v58, 24, v34
    v_lshl_add_u32 v59, v58, 2, s72
    s_mov_b64 exec, s[44:45]
    ds_add_rtn_u32 v55, v55, v64
    s_mov_b64 exec, s[46:47]
    ds_add_rtn_u32 v59, v59, v64
    s_mov_b64 exec, -1
    v_lshlrev_b32 v52, 16, v33
    v_and_b32 v56, 0xffff0000, v33
    v_mul_f32 v52, 0.15915494, v52
    v_mul_f32 v56, 0.15915494, v56
    v_fract_f32 v52, v52
    v_fract_f32 v56, v56
    v_cos_f32 v52, v52
    v_cos_f32 v56, v56
    v_fma_f32 v0, v52, v52, -0.5
    v_fma_f32 v1, v56, v56, -0.5
    v_cvt_pk_bf16_f32 v52, v52, v0
    v_cvt_pk_bf16_f32 v56, v56, v1
    v_perm_b32 v53, v32, v32, s33
    v_perm_b32 v57, v34, v34, s33
SK_59:
    s_waitcnt vmcnt(3)
    ds_read_b64_tr_b16 v[20:21], v50
    ds_read_b64_tr_b16 v[22:23], v50 offset:512
    s_waitcnt lgkmcnt(0)
    v_mfma_f32_16x16x32_bf16 v[116:119], v[20:23], v[12:15], v[116:119]
    s_mov_b32 m0, s76
    v_lshrrev_b32 v51, 8, v51
    v_sub_u32_dpp v1, v43, v31 row_newbcast:7 row_mask:0xf bank_mask:0xf
    v_bfi_b32 v51, s32, v51, v1
    buffer_load_dwordx4 v51, s[8:11], 0 offen  lds
    v_and_b32_dpp v12, v24, v47 quad_perm:[2,2,2,2] row_mask:0xf bank_mask:0xf
    v_and_b32_dpp v13, v25, v47 quad_perm:[2,2,2,2] row_mask:0xf bank_mask:0xf
    v_and_b32_dpp v14, v26, v47 quad_perm:[2,2,2,2] row_mask:0xf bank_mask:0xf
    v_and_b32_dpp v15, v27, v47 quad_perm:[2,2,2,2] row_mask:0xf bank_mask:0xf
    v_perm_b32 v12, v3, v2, v12
    v_perm_b32 v13, v3, v2, v13
    v_perm_b32 v14, v3, v2, v14
    v_perm_b32 v15, v3, v2, v15
    v_and_b32_dpp v12, v24, v12 quad_perm:[0,1,0,1] row_mask:0xf bank_mask:0xf
    v_and_b32_dpp v13, v25, v13 quad_perm:[0,1,0,1] row_mask:0xf bank_mask:0xf
    v_and_b32_dpp v14, v26, v14 quad_perm:[0,1,0,1] row_mask:0xf bank_mask:0xf
    v_and_b32_dpp v15, v27, v15 quad_perm:[0,1,0,1] row_mask:0xf bank_mask:0xf
    s_or_b64 s[64:65], s[44:45], s[46:47]
    s_cbranch_scc0 SK_60
    s_mov_b64 exec, s[44:45]
    v_cmp_gt_u32 vcc, s26, v55
    v_mad_u32_u24 v55, v54, s31, v55
    s_andn2_b64 s[62:63], s[44:45], vcc
    s_cbranch_scc1 RARE_61
BACK_62:
    s_mov_b64 exec, vcc
    ds_write_b64 v55, v[52:53]
    s_mov_b64 exec, s[46:47]
    v_cmp_gt_u32 vcc, s26, v59
    v_mad_u32_u24 v59, v58, s31, v59
    s_andn2_b64 s[62:63], s[46:47], vcc
    s_cbranch_scc1 RARE_63
BACK_64:
    s_mov_b64 exec, vcc
    ds_write_b64 v59, v[56:57]
    s_mov_b64 exec, -1
SK_60:
    s_cmp_eq_u32 s28, 5
    s_cbranch_scc1 SD_65
    v_add_u32_dpp v1, v62, v44 row_newbcast:4 row_mask:0xf bank_mask:0xf
    v_sub_u32_dpp v0, v63, v44 row_newbcast:4 row_mask:0xf bank_mask:0xf
    s_lshr_b64 s[64:65], s[66:67], 4
    v_cmp_lt_i32 s[44:45], 0, v0
    v_cmp_lt_i32 s[46:47], 6, v0
    s_or_b64 s[64:65], s[64:65], s[78:79]
    v_cndmask_b32 v1, -1, v1, s[44:45]
    buffer_load_dwordx3 v[32:34], v1, s[12:15], 0 offen
    s_and_b64 s[44:45], s[44:45], s[64:65]
SDE_66:
    s_setprio 1
    ds_read_b32 v51, v35 offset:25348
    ds_read_b64_tr_b16 v[24:25], v39 offset:25344
    ds_read_b64_tr_b16 v[26:27], v39 offset:25472
    s_waitcnt vmcnt(4)
    ds_read_b64_tr_b16 v[20:21], v48
    ds_read_b64_tr_b16 v[22:23], v48 offset:512
    s_waitcnt lgkmcnt(0)
    v_mfma_f32_16x16x32_bf16 v[112:115], v[20:23], v[4:7], v[112:115]
    s_mov_b32 m0, s74
    v_lshrrev_b32 v51, 8, v51
    v_sub_u32_dpp v1, v43, v31 row_newbcast:6 row_mask:0xf bank_mask:0xf
    v_bfi_b32 v51, s32, v51, v1
    buffer_load_dwordx4 v51, s[8:11], 0 offen  lds
    v_and_b32_dpp v4, v24, v47 quad_perm:[2,2,2,2] row_mask:0xf bank_mask:0xf
    v_and_b32_dpp v5, v25, v47 quad_perm:[2,2,2,2] row_mask:0xf bank_mask:0xf
    v_and_b32_dpp v6, v26, v47 quad_perm:[2,2,2,2] row_mask:0xf bank_mask:0xf
    v_and_b32_dpp v7, v27, v47 quad_perm:[2,2,2,2] row_mask:0xf bank_mask:0xf
    v_perm_b32 v4, v3, v2, v4
    v_perm_b32 v5, v3, v2, v5
    v_perm_b32 v6, v3, v2, v6
    v_perm_b32 v7, v3, v2, v7
    v_and_b32_dpp v4, v24, v4 quad_perm:[0,1,0,1] row_mask:0xf bank_mask:0xf
    v_and_b32_dpp v5, v25, v5 quad_perm:[0,1,0,1] row_mask:0xf bank_mask:0xf
    v_and_b32_dpp v6, v26, v6 quad_perm:[0,1,0,1] row_mask:0xf bank_mask:0xf
    v_and_b32_dpp v7, v27, v7 quad_perm:[0,1,0,1] row_mask:0xf bank_mask:0xf
    s_cmp_eq_u32 s77, 0
    s_cbranch_scc0 NP_67
    v_cvt_pk_bf16_f32 v52, v116, v117
    v_cvt_pk_bf16_f32 v53, v118, v119
    v_cvt_pk_bf16_f32 v56, v120, v121
    v_cvt_pk_bf16_f32 v57, v122, v123
    v_add_u32 v38, 2560, v60
    s_mov_b32 s63, -1
    s_mov_b32 s62, 0
    v_cndmask_b32 v36, 0, v72, s[62:63]
    v_cndmask_b32 v37, 0, v73, s[62:63]
    s_mov_b64 s[64:65], -1
    s_call_b64 s[98:99], K2_PAIR
NP_67:
    ds_read_b32 v51, v35 offset:21124
    ds_read_b64_tr_b16 v[24:25], v39 offset:21120
    ds_read_b64_tr_b16 v[26:27], v39 offset:21248
    s_or_b64 s[64:65], s[48:49], s[50:51]
    s_cbranch_scc0 SK_68
    v_lshrrev_b32 v54, 24, v36
    v_lshl_add_u32 v55, v54, 2, s72
    v_lshrrev_b32 v58, 24, v38
    v_lshl_add_u32 v59, v58, 2, s72
    s_mov_b64 exec, s[48:49]
    ds_add_rtn_u32 v55, v55, v64
    s_mov_b64 exec, s[50:51]
    ds_add_rtn_u32 v59, v59, v64
    s_mov_b64 exec, -1
    v_lshlrev_b32 v52, 16, v37
    v_and_b32 v56, 0xffff0000, v37
    v_mul_f32 v52, 0.15915494, v52
    v_mul_f32 v56, 0.15915494, v56
    v_fract_f32 v52, v52
    v_fract_f32 v56, v56
    v_cos_f32 v52, v52
    v_cos_f32 v56, v56
    v_fma_f32 v0, v52, v52, -0.5
    v_fma_f32 v1, v56, v56, -0.5
    v_cvt_pk_bf16_f32 v52, v52, v0
    v_cvt_pk_bf16_f32 v56, v56, v1
    v_perm_b32 v53, v36, v36, s33
    v_perm_b32 v57, v38, v38, s33
SK_68:
    s_waitcnt vmcnt(4)
    ds_read_b64_tr_b16 v[20:21], v49
    ds_read_b64_tr_b16 v[22:23], v49 offset:512
    s_waitcnt lgkmcnt(0)
    v_mfma_f32_16x16x32_bf16 v[108:111], v[20:23], v[8:11], v[108:111]
    s_mov_b32 m0, s75
    v_lshrrev_b32 v51, 8, v51
    v_sub_u32_dpp v1, v43, v31 row_newbcast:5 row_mask:0xf bank_mask:0xf
    v_bfi_b32 v51, s32, v51, v1
    buffer_load_dwordx4 v51, s[8:11], 0 offen  lds
    v_and_b32_dpp v8, v24, v47 quad_perm:[2,2,2,2] row_mask:0xf bank_mask:0xf
    v_and_b32_dpp v9, v25, v47 quad_perm:[2,2,2,2] row_mask:0xf bank_mask:0xf
    v_and_b32_dpp v10, v26, v47 quad_perm:[2,2,2,2] row_mask:0xf bank_mask:0xf
    v_and_b32_dpp v11, v27, v47 quad_perm:[2,2,2,2] row_mask:0xf bank_mask:0xf
    v_perm_b32 v8, v3, v2, v8
    v_perm_b32 v9, v3, v2, v9
    v_perm_b32 v10, v3, v2, v10
    v_perm_b32 v11, v3, v2, v11
    v_and_b32_dpp v8, v24, v8 quad_perm:[0,1,0,1] row_mask:0xf bank_mask:0xf
    v_and_b32_dpp v9, v25, v9 quad_perm:[0,1,0,1] row_mask:0xf bank_mask:0xf
    v_and_b32_dpp v10, v26, v10 quad_perm:[0,1,0,1] row_mask:0xf bank_mask:0xf
    v_and_b32_dpp v11, v27, v11 quad_perm:[0,1,0,1] row_mask:0xf bank_mask:0xf
    s_or_b64 s[64:65], s[48:49], s[50:51]
    s_cbranch_scc0 SK_69
    s_mov_b64 exec, s[48:49]
    v_cmp_gt_u32 vcc, s26, v55
    v_mad_u32_u24 v55, v54, s31, v55
    s_andn2_b64 s[62:63], s[48:49], vcc
    s_cbranch_scc1 RARE_70
BACK_71:
    s_mov_b64 exec, vcc
    ds_write_b64 v55, v[52:53]
    s_mov_b64 exec, s[50:51]
    v_cmp_gt_u32 vcc, s26, v59
    v_mad_u32_u24 v59, v58, s31, v59
    s_andn2_b64 s[62:63], s[50:51], vcc
    s_cbranch_scc1 RARE_72
BACK_73:
    s_mov_b64 exec, vcc
    ds_write_b64 v59, v[56:57]
    s_mov_b64 exec, -1
SK_69:
    s_cmp_eq_u32 s28, 5
    s_cbranch_scc1 SD_74
    v_add_u32_dpp v1, v62, v44 row_newbcast:8 row_mask:0xf bank_mask:0xf
    v_sub_u32_dpp v0, v63, v44 row_newbcast:8 row_mask:0xf bank_mask:0xf
    s_lshr_b64 s[64:65], s[66:67], 8
    v_cmp_lt_i32 s[48:49], 0, v0
    v_cmp_lt_i32 s[50:51], 6, v0
    s_or_b64 s[64:65], s[64:65], s[78:79]
    v_cndmask_b32 v1, -1, v1, s[48:49]
    buffer_load_dwordx3 v[36:38], v1, s[12:15], 0 offen
    s_and_b64 s[48:49], s[48:49], s[64:65]
SDE_75:
    ds_read_b32 v51, v35 offset:16900
    ds_read_b64_tr_b16 v[24:25], v39 offset:16896
    ds_read_b64_tr_b16 v[26:27], v39 offset:17024
    s_or_b64 s[64:65], s[52:53], s[54:55]
    s_cbranch_scc0 SK_76
    v_lshrrev_b32 v54, 24, v40
    v_lshl_add_u32 v55, v54, 2, s72
    v_lshrrev_b32 v58, 24, v42
    v_lshl_add_u32 v59, v58, 2, s72
    s_mov_b64 exec, s[52:53]
    ds_add_rtn_u32 v55, v55, v64
    s_mov_b64 exec, s[54:55]
    ds_add_rtn_u32 v59, v59, v64
    s_mov_b64 exec, -1
    v_lshlrev_b32 v52, 16, v41
    v_and_b32 v56, 0xffff0000, v41
    v_mul_f32 v52, 0.15915494, v52
    v_mul_f32 v56, 0.15915494, v56
    v_fract_f32 v52, v52
    v_fract_f32 v56, v56
    v_cos_f32 v52, v52
    v_cos_f32 v56, v56
    v_fma_f32 v0, v52, v52, -0.5
    v_fma_f32 v1, v56, v56, -0.5
    v_cvt_pk_bf16_f32 v52, v52, v0
    v_cvt_pk_bf16_f32 v56, v56, v1
    v_perm_b32 v53, v40, v40, s33
    v_perm_b32 v57, v42, v42, s33
SK_76:
    s_waitcnt vmcnt(4)
    ds_read_b64_tr_b16 v[20:21], v50
    ds_read_b64_tr_b16 v[22:23], v50 offset:512
    s_waitcnt lgkmcnt(0)
    v_mfma_f32_16x16x32_bf16 v[104:107], v[20:23], v[12:15], v[104:107]
    s_mov_b32 m0, s76
    v_lshrrev_b32 v51, 8, v51
    v_sub_u32_dpp v1, v43, v31 row_newbcast:4 row_mask:0xf bank_mask:0xf
    v_bfi_b32 v51, s32, v51, v1
    buffer_load_dwordx4 v51, s[8:11], 0 offen  lds
    v_and_b32_dpp v12, v24, v47 quad_perm:[2,2,2,2] row_mask:0xf bank_mask:0xf
    v_and_b32_dpp v13, v25, v47 quad_perm:[2,2,2,2] row_mask:0xf bank_mask:0xf
    v_and_b32_dpp v14, v26, v47 quad_perm:[2,2,2,2] row_mask:0xf bank_mask:0xf
    v_and_b32_dpp v15, v27, v47 quad_perm:[2,2,2,2] row_mask:0xf bank_mask:0xf
    v_perm_b32 v12, v3, v2, v12
    v_perm_b32 v13, v3, v2, v13
    v_perm_b32 v14, v3, v2, v14
    v_perm_b32 v15, v3, v2, v15
    v_and_b32_dpp v12, v24, v12 quad_perm:[0,1,0,1] row_mask:0xf bank_mask:0xf
    v_and_b32_dpp v13, v25, v13 quad_perm:[0,1,0,1] row_mask:0xf bank_mask:0xf
    v_and_b32_dpp v14, v26, v14 quad_perm:[0,1,0,1] row_mask:0xf bank_mask:0xf
    v_and_b32_dpp v15, v27, v15 quad_perm:[0,1,0,1] row_mask:0xf bank_mask:0xf
    s_or_b64 s[64:65], s[52:53], s[54:55]
    s_cbranch_scc0 SK_77
    s_mov_b64 exec, s[52:53]
    v_cmp_gt_u32 vcc, s26, v55
    v_mad_u32_u24 v55, v54, s31, v55
    s_andn2_b64 s[62:63], s[52:53], vcc
    s_cbranch_scc1 RARE_78
BACK_79:
    s_mov_b64 exec, vcc
    ds_write_b64 v55, v[52:53]
    s_mov_b64 exec, s[54:55]
    v_cmp_gt_u32 vcc, s26, v59
    v_mad_u32_u24 v59, v58, s31, v59
    s_andn2_b64 s[62:63], s[54:55], vcc
    s_cbranch_scc1 RARE_80
BACK_81:
    s_mov_b64 exec, vcc
    ds_write_b64 v59, v[56:57]
    s_mov_b64 exec, -1
SK_77:
    s_lshl_b32 s38, s30, 16
    s_or_b32 s38, s38, s29
    s_cmp_eq_u32 s28, 4
    s_cselect_b32 s38, s38, 0
    s_cmp_lg_u32 s38, 0
    s_cbranch_scc1 SD_82
SDE_83:
    s_mov_b64 exec, 1
    ds_add_u32 v67, v64 offset:2068
    s_mov_b64 exec, -1
    s_cmp_eq_u32 s28, 5
    s_cbranch_scc1 SD_84
    v_add_u32_dpp v1, v62, v44 row_newbcast:12 row_mask:0xf bank_mask:0xf
    v_sub_u32_dpp v0, v63, v44 row_newbcast:12 row_mask:0xf bank_mask:0xf
    s_lshr_b64 s[64:65], s[66:67], 12
    v_cmp_lt_i32 s[52:53], 0, v0
    v_cmp_lt_i32 s[54:55], 6, v0
    s_or_b64 s[64:65], s[64:65], s[78:79]
    v_cndmask_b32 v1, -1, v1, s[52:53]
    buffer_load_dwordx3 v[40:42], v1, s[12:15], 0 offen
    s_and_b64 s[52:53], s[52:53], s[64:65]
SDE_85:
    s_cmp_eq_u32 s77, 0
    s_cbranch_scc0 NP_86
    v_cvt_pk_bf16_f32 v52, v108, v109
    v_cvt_pk_bf16_f32 v53, v110, v111
    v_cvt_pk_bf16_f32 v56, v112, v113
    v_cvt_pk_bf16_f32 v57, v114, v115
    v_add_u32 v38, 2048, v60
    s_mov_b32 s62, -1
    s_mov_b32 s63, 0
    v_cndmask_b32 v36, 0, v72, s[62:63]
    v_cndmask_b32 v37, 0, v73, s[62:63]
    s_mov_b64 s[64:65], -1
    s_call_b64 s[98:99], K2_PAIR
    ds_read_b128 v[52:55], v61 offset:2048
    v_add_u32 v51, 32768, v62
    s_waitcnt lgkmcnt(0)
    buffer_store_dwordx4 v[52:55], v51, s[16:19], 0 offen sc0 sc1
    s_nop 1
NP_86:
    s_setprio 0
    ds_read_b32 v51, v35 offset:12676
    ds_read_b64_tr_b16 v[24:25], v39 offset:12672
    ds_read_b64_tr_b16 v[26:27], v39 offset:12800
    s_waitcnt vmcnt(4)
    ds_read_b64_tr_b16 v[20:21], v48
    ds_read_b64_tr_b16 v[22:23], v48 offset:512
    s_waitcnt lgkmcnt(0)
    v_mfma_f32_16x16x32_bf16 v[100:103], v[20:23], v[4:7], v[100:103]
    s_mov_b32 m0, s74
    v_lshrrev_b32 v51, 8, v51
    v_sub_u32_dpp v1, v43, v31 row_newbcast:3 row_mask:0xf bank_mask:0xf
    v_bfi_b32 v51, s32, v51, v1
    buffer_load_dwordx4 v51, s[8:11], 0 offen  lds
    v_and_b32_dpp v4, v24, v47 quad_perm:[2,2,2,2] row_mask:0xf bank_mask:0xf
    v_and_b32_dpp v5, v25, v47 quad_perm:[2,2,2,2] row_mask:0xf bank_mask:0xf
    v_and_b32_dpp v6, v26, v47 quad_perm:[2,2,2,2] row_mask:0xf bank_mask:0xf
    v_and_b32_dpp v7, v27, v47 quad_perm:[2,2,2,2] row_mask:0xf bank_mask:0xf
    v_perm_b32 v4, v3, v2, v4
    v_perm_b32 v5, v3, v2, v5
    v_perm_b32 v6, v3, v2, v6
    v_perm_b32 v7, v3, v2, v7
    v_and_b32_dpp v4, v24, v4 quad_perm:[0,1,0,1] row_mask:0xf bank_mask:0xf
    v_and_b32_dpp v5, v25, v5 quad_perm:[0,1,0,1] row_mask:0xf bank_mask:0xf
    v_and_b32_dpp v6, v26, v6 quad_perm:[0,1,0,1] row_mask:0xf bank_mask:0xf
    v_and_b32_dpp v7, v27, v7 quad_perm:[0,1,0,1] row_mask:0xf bank_mask:0xf
    s_cmp_lt_u32 s24, 4
    s_cselect_b32 s38, s77, 1
    s_cmp_eq_u32 s38, 0
    s_cbranch_scc0 NP_87
    v_cvt_pk_bf16_f32 v52, v124, v125
    v_cvt_pk_bf16_f32 v53, v126, v127
    v_cvt_pk_bf16_f32 v56, v124, v125
    v_cvt_pk_bf16_f32 v57, v126, v127
    v_add_u32 v38, 3072, v60
    s_mov_b32 s62, -1
    s_mov_b32 s63, 0
    v_cndmask_b32 v36, 0, v74, s[62:63]
    v_cndmask_b32 v37, 0, v75, s[62:63]
    s_mov_b64 s[64:65], 0x55555555
    s_mov_b32 s65, 0x55555555
    s_call_b64 s[98:99], K2_PAIR
    s_mov_b64 exec, 0xffff
    ds_read_b128 v[52:55], v61 offset:3072
    v_add_u32 v51, 49152, v62
    s_waitcnt lgkmcnt(0)
    buffer_store_dwordx4 v[52:55], v51, s[16:19], 0 offen sc0 sc1
    s_mov_b64 exec, -1
    s_nop 0
NP_87:
    ds_read_b32 v51, v35 offset:8452
    ds_read_b64_tr_b16 v[24:25], v39 offset:8448
    ds_read_b64_tr_b16 v[26:27], v39 offset:8576
    s_waitcnt vmcnt(4)
    ds_read_b64_tr_b16 v[20:21], v49
    ds_read_b64_tr_b16 v[22:23], v49 offset:512
    s_waitcnt lgkmcnt(0)
    v_mfma_f32_16x16x32_bf16 v[96:99], v[20:23], v[8:11], v[96:99]
    s_mov_b32 m0, s75
    v_lshrrev_b32 v51, 8, v51
    v_sub_u32_dpp v1, v43, v31 row_newbcast:2 row_mask:0xf bank_mask:0xf
    v_bfi_b32 v51, s32, v51, v1
    buffer_load_dwordx4 v51, s[8:11], 0 offen  lds
    v_and_b32_dpp v8, v24, v47 quad_perm:[2,2,2,2] row_mask:0xf bank_mask:0xf
    v_and_b32_dpp v9, v25, v47 quad_perm:[2,2,2,2] row_mask:0xf bank_mask:0xf
    v_and_b32_dpp v10, v26, v47 quad_perm:[2,2,2,2] row_mask:0xf bank_mask:0xf
    v_and_b32_dpp v11, v27, v47 quad_perm:[2,2,2,2] row_mask:0xf bank_mask:0xf
    v_perm_b32 v8, v3, v2, v8
    v_perm_b32 v9, v3, v2, v9
    v_perm_b32 v10, v3, v2, v10
    v_perm_b32 v11, v3, v2, v11
    v_and_b32_dpp v8, v24, v8 quad_perm:[0,1,0,1] row_mask:0xf bank_mask:0xf
    v_and_b32_dpp v9, v25, v9 quad_perm:[0,1,0,1] row_mask:0xf bank_mask:0xf
    v_and_b32_dpp v10, v26, v10 quad_perm:[0,1,0,1] row_mask:0xf bank_mask:0xf
    v_and_b32_dpp v11, v27, v11 quad_perm:[0,1,0,1] row_mask:0xf bank_mask:0xf
    s_cmp_eq_u32 s77, 0
    s_cbranch_scc0 NP_88
    v_cvt_pk_bf16_f32 v52, v100, v101
    v_cvt_pk_bf16_f32 v53, v102, v103
    v_cvt_pk_bf16_f32 v56, v104, v105
    v_cvt_pk_bf16_f32 v57, v106, v107
    v_add_u32 v38, 1536, v60
    s_mov_b32 s63, -1
    s_mov_b32 s62, 0
    v_cndmask_b32 v36, 0, v70, s[62:63]
    v_cndmask_b32 v37, 0, v71, s[62:63]
    s_mov_b64 s[64:65], -1
    s_call_b64 s[98:99], K2_PAIR
NP_88:
    ds_read_b32 v51, v35 offset:4228
    ds_read_b64_tr_b16 v[24:25], v39 offset:4224
    ds_read_b64_tr_b16 v[26:27], v39 offset:4352
    s_waitcnt vmcnt(3)
    ds_read_b64_tr_b16 v[20:21], v50
    ds_read_b64_tr_b16 v[22:23], v50 offset:512
    s_waitcnt lgkmcnt(0)
    v_mfma_f32_16x16x32_bf16 v[92:95], v[20:23], v[12:15], v[92:95]
    s_mov_b32 m0, s76
    v_lshrrev_b32 v51, 8, v51
    v_sub_u32_dpp v1, v43, v31 row_newbcast:1 row_mask:0xf bank_mask:0xf
    v_bfi_b32 v51, s32, v51, v1
    buffer_load_dwordx4 v51, s[8:11], 0 offen  lds
    v_and_b32_dpp v12, v24, v47 quad_perm:[2,2,2,2] row_mask:0xf bank_mask:0xf
    v_and_b32_dpp v13, v25, v47 quad_perm:[2,2,2,2] row_mask:0xf bank_mask:0xf
    v_and_b32_dpp v14, v26, v47 quad_perm:[2,2,2,2] row_mask:0xf bank_mask:0xf
    v_and_b32_dpp v15, v27, v47 quad_perm:[2,2,2,2] row_mask:0xf bank_mask:0xf
    v_perm_b32 v12, v3, v2, v12
    v_perm_b32 v13, v3, v2, v13
    v_perm_b32 v14, v3, v2, v14
    v_perm_b32 v15, v3, v2, v15
    v_and_b32_dpp v12, v24, v12 quad_perm:[0,1,0,1] row_mask:0xf bank_mask:0xf
    v_and_b32_dpp v13, v25, v13 quad_perm:[0,1,0,1] row_mask:0xf bank_mask:0xf
    v_and_b32_dpp v14, v26, v14 quad_perm:[0,1,0,1] row_mask:0xf bank_mask:0xf
    v_and_b32_dpp v15, v27, v15 quad_perm:[0,1,0,1] row_mask:0xf bank_mask:0xf
    ds_read_b32 v51, v35 offset:4
    ds_read_b64_tr_b16 v[24:25], v39 offset:0
    ds_read_b64_tr_b16 v[26:27], v39 offset:128
    ds_read_b32 v46, v67 offset:2068
    s_waitcnt vmcnt(2)
    ds_read_b64_tr_b16 v[20:21], v48
    ds_read_b64_tr_b16 v[22:23], v48 offset:512
    s_waitcnt lgkmcnt(0)
    s_mov_b64 exec, 1
    ds_add_u32 v67, v64 offset:2064
    s_mov_b64 exec, -1
    v_readfirstlane_b32 s5, v46
    v_mfma_f32_16x16x32_bf16 v[88:91], v[20:23], v[4:7], v[88:91]
    s_mov_b32 m0, s74
    v_lshrrev_b32 v51, 8, v51
    v_sub_u32_dpp v1, v43, v31 row_newbcast:0 row_mask:0xf bank_mask:0xf
    v_bfi_b32 v51, s32, v51, v1
    buffer_load_dwordx4 v51, s[8:11], 0 offen  lds
    v_and_b32_dpp v16, v24, v47 quad_perm:[2,2,2,2] row_mask:0xf bank_mask:0xf
    v_and_b32_dpp v17, v25, v47 quad_perm:[2,2,2,2] row_mask:0xf bank_mask:0xf
    v_and_b32_dpp v18, v26, v47 quad_perm:[2,2,2,2] row_mask:0xf bank_mask:0xf
    v_and_b32_dpp v19, v27, v47 quad_perm:[2,2,2,2] row_mask:0xf bank_mask:0xf
    v_perm_b32 v16, v3, v2, v16
    v_perm_b32 v17, v3, v2, v17
    v_perm_b32 v18, v3, v2, v18
    v_perm_b32 v19, v3, v2, v19
    v_and_b32_dpp v16, v24, v16 quad_perm:[0,1,0,1] row_mask:0xf bank_mask:0xf
    v_and_b32_dpp v17, v25, v17 quad_perm:[0,1,0,1] row_mask:0xf bank_mask:0xf
    v_and_b32_dpp v18, v26, v18 quad_perm:[0,1,0,1] row_mask:0xf bank_mask:0xf
    v_and_b32_dpp v19, v27, v19 quad_perm:[0,1,0,1] row_mask:0xf bank_mask:0xf
    s_cmp_eq_u32 s77, 0
    s_cbranch_scc0 NP_89
    v_cvt_pk_bf16_f32 v52, v92, v93
    v_cvt_pk_bf16_f32 v53, v94, v95
    v_cvt_pk_bf16_f32 v56, v96, v97
    v_cvt_pk_bf16_f32 v57, v98, v99
    v_add_u32 v38, 1024, v60
    s_mov_b32 s62, -1
    s_mov_b32 s63, 0
    v_cndmask_b32 v36, 0, v70, s[62:63]
    v_cndmask_b32 v37, 0, v71, s[62:63]
    s_mov_b64 s[64:65], -1
    s_call_b64 s[98:99], K2_PAIR
    ds_read_b128 v[52:55], v61 offset:1024
    v_add_u32 v51, 16384, v62
    s_waitcnt lgkmcnt(0)
    buffer_store_dwordx4 v[52:55], v51, s[16:19], 0 offen sc0 sc1
    s_nop 1
NP_89:
    s_add_u32 s7, s7, 128
    s_add_u32 s4, s4, 128
    v_add_u32 v35, s27, v35
    v_add_u32 v39, s27, v39
    v_mov_b32 v0, v48
    v_mov_b32 v48, v49
    v_mov_b32 v49, v50
    v_mov_b32 v50, v0
    s_mov_b32 s38, s74
    s_mov_b32 s74, s75
    s_mov_b32 s75, s76
    s_mov_b32 s76, s38
    s_sub_u32 s26, s26, s27
    s_add_u32 s73, s73, s27
    s_sub_u32 s27, 0, s27
    s_add_u32 s28, s28, 1
    s_cmp_lt_u32 s28, 6
    s_cbranch_scc1 K2_LOOP
    s_cmp_lg_u32 s35, 0
    s_cbranch_scc1 K2_GEN0
    s_waitcnt vmcnt(3)
    ds_read_b64_tr_b16 v[20:21], v48
    ds_read_b64_tr_b16 v[22:23], v48 offset:512
    s_waitcnt lgkmcnt(0)
    v_mfma_f32_16x16x32_bf16 v[84:87], v[20:23], v[8:11], v[84:87]
    s_waitcnt vmcnt(2)
    ds_read_b64_tr_b16 v[20:21], v49
    ds_read_b64_tr_b16 v[22:23], v49 offset:512
    s_waitcnt lgkmcnt(0)
    v_mfma_f32_16x16x32_bf16 v[80:83], v[20:23], v[12:15], v[80:83]
    s_nop 2
    v_cvt_pk_bf16_f32 v52, v84, v85
    v_cvt_pk_bf16_f32 v53, v86, v87
    v_cvt_pk_bf16_f32 v56, v88, v89
    v_cvt_pk_bf16_f32 v57, v90, v91
    v_add_u32 v38, 512, v60
    s_mov_b32 s63, -1
    s_mov_b32 s62, 0
    v_cndmask_b32 v36, 0, v68, s[62:63]
    v_cndmask_b32 v37, 0, v69, s[62:63]
    s_mov_b64 s[64:65], -1
    s_call_b64 s[98:99], K2_PAIR
    s_waitcnt vmcnt(1)
    ds_read_b64_tr_b16 v[20:21], v50
    ds_read_b64_tr_b16 v[22:23], v50 offset:512
    s_waitcnt lgkmcnt(0)
    v_mfma_f32_16x16x32_bf16 v[76:79], v[20:23], v[16:19], v[76:79]
K2_EPI_B:
    s_nop 7
    v_cvt_pk_bf16_f32 v52, v76, v77
    v_cvt_pk_bf16_f32 v53, v78, v79
    v_cvt_pk_bf16_f32 v56, v80, v81
    v_cvt_pk_bf16_f32 v57, v82, v83
    v_add_u32 v38, 0, v60
    s_mov_b32 s62, -1
    s_mov_b32 s63, 0
    v_cndmask_b32 v36, 0, v68, s[62:63]
    v_cndmask_b32 v37, 0, v69, s[62:63]
    s_mov_b64 s[64:65], -1
    s_call_b64 s[98:99], K2_PAIR
    ds_read_b128 v[52:55], v61 offset:0
    v_add_u32 v51, 0, v62
    s_waitcnt lgkmcnt(0)
    buffer_store_dwordx4 v[52:55], v51, s[16:19], 0 offen sc0 sc1
K2_END:
    s_endpgm
K2_GEN:
    s_waitcnt vmcnt(0) lgkmcnt(0)
    s_nop 7
    s_mul_i32 s38, s24, 264
    s_add_u32 s38, s38, 59968
    v_lshrrev_b32 v0, 2, v65
    v_lshl_add_u32 v39, v0, 3, s38
    v_lshrrev_b32 v0, 1, v65
    v_lshl_add_u32 v35, v0, 3, s38
    s_mov_b32 s26, 60224
    s_mov_b32 s73, 59968
    s_mov_b32 s72, 0
    s_mov_b32 s27, 0
    s_mov_b64 s[46:47], 0
    s_cmp_ge_u32 s35, 0x100
    s_cbranch_scc1 K2_GSLOW
    v_lshl_add_u32 v0, v65, 3, s34
    ds_read_b32 v28, v0
    ds_read_b32 v52, v0 offset:4
    v_cmp_gt_u32 s[44:45], s29, v65
    s_mov_b32 s28, 6
    s_waitcnt lgkmcnt(0)
    s_barrier
    s_branch K2_GINS
K2_GSLOW:
    v_mov_b32 v76, 0
    v_mov_b32 v77, 0
    v_mov_b32 v78, 0
    v_mov_b32 v79, 0
    v_mov_b32 v80, 0
    v_mov_b32 v81, 0
    v_mov_b32 v82, 0
    v_mov_b32 v83, 0
    v_mov_b32 v84, 0
    v_mov_b32 v85, 0
    v_mov_b32 v86, 0
    v_mov_b32 v87, 0
    v_mov_b32 v88, 0
    v_mov_b32 v89, 0
    v_mov_b32 v90, 0
    v_mov_b32 v91, 0
    v_mov_b32 v92, 0
    v_mov_b32 v93, 0
    v_mov_b32 v94, 0
    v_mov_b32 v95, 0
    v_mov_b32 v96, 0
    v_mov_b32 v97, 0
    v_mov_b32 v98, 0
    v_mov_b32 v99, 0
    v_mov_b32 v100, 0
    v_mov_b32 v101, 0
    v_mov_b32 v102, 0
    v_mov_b32 v103, 0
    v_mov_b32 v104, 0
    v_mov_b32 v105, 0
    v_mov_b32 v106, 0
    v_mov_b32 v107, 0
    v_mov_b32 v108, 0
    v_mov_b32 v109, 0
    v_mov_b32 v110, 0
    v_mov_b32 v111, 0
    v_mov_b32 v112, 0
    v_mov_b32 v113, 0
    v_mov_b32 v114, 0
    v_mov_b32 v115, 0
    v_mov_b32 v116, 0
    v_mov_b32 v117, 0
    v_mov_b32 v118, 0
    v_mov_b32 v119, 0
    v_mov_b32 v120, 0
    v_mov_b32 v121, 0
    v_mov_b32 v122, 0
    v_mov_b32 v123, 0
    v_mov_b32 v124, 0
    v_mov_b32 v125, 0
    v_mov_b32 v126, 0
    v_mov_b32 v127, 0
    s_mov_b64 s[44:45], 0
    s_mov_b32 s28, 0
    s_mov_b32 s37, 0
    v_and_b32 v1, 3, v65
    s_sub_u32 s38, s37, 4
    v_cmp_eq_u32 vcc, s37, v1
    v_cmp_eq_u32 s[66:67], s38, v1
    s_nop 0
    v_cndmask_b32 v0, 0, v60, vcc
    v_cndmask_b32 v0, v0, v61, s[66:67]
    s_nop 1
    v_or_b32_dpp v0, v0, v0 quad_perm:[1,0,3,2] row_mask:0xf bank_mask:0xf
    s_nop 1
    v_or_b32_dpp v0, v0, v0 quad_perm:[2,3,0,1] row_mask:0xf bank_mask:0xf
    v_bfe_u32 v62, v0, 1, 15
    v_lshrrev_b32 v63, 16, v0
    v_add_u32 v1, v62, v1
    v_and_b32 v0, 0xffff, v0
    v_mad_u32_u24 v62, v1, 12, v45
    v_lshlrev_b32 v1, 1, v1
    v_sub_u32 v63, v63, v1
    v_cmp_ge_u32 s[66:67], v1, v0
    v_cmp_lt_i32 s[68:69], 32, v63
    v_mul_i32_i24 v63, 6, v63
    s_barrier
    s_nop 2
K2_GTOP:
    s_or_b64 s[64:65], s[44:45], s[46:47]
    s_cbranch_scc1 K2_GINS
K2_GNEXT:
    s_cmp_ge_u32 s28, 6
    s_cbranch_scc1 K2_GINS
    v_cmp_lt_i32 s[44:45], 0, v63
    s_nop 0
    s_cmp_lg_u64 s[44:45], 0
    s_cbranch_scc1 K2_GFETCH
    s_add_u32 s28, s28, 1
    s_mov_b32 s37, s28
    v_and_b32 v1, 3, v65
    s_sub_u32 s38, s37, 4
    v_cmp_eq_u32 vcc, s37, v1
    v_cmp_eq_u32 s[66:67], s38, v1
    s_nop 0
    v_cndmask_b32 v0, 0, v60, vcc
    v_cndmask_b32 v0, v0, v61, s[66:67]
    s_nop 1
    v_or_b32_dpp v0, v0, v0 quad_perm:[1,0,3,2] row_mask:0xf bank_mask:0xf
    s_nop 1
    v_or_b32_dpp v0, v0, v0 quad_perm:[2,3,0,1] row_mask:0xf bank_mask:0xf
    v_bfe_u32 v62, v0, 1, 15
    v_lshrrev_b32 v63, 16, v0
    v_add_u32 v1, v62, v1
    v_and_b32 v0, 0xffff, v0
    v_mad_u32_u24 v62, v1, 12, v45
    v_lshlrev_b32 v1, 1, v1
    v_sub_u32 v63, v63, v1
    v_cmp_ge_u32 s[66:67], v1, v0
    v_cmp_lt_i32 s[68:69], 32, v63
    v_mul_i32_i24 v63, 6, v63
    s_nop 3
    s_branch K2_GNEXT
K2_GFETCH:
    s_nop 4
    v_cmp_lt_i32 s[46:47], 6, v63
    v_cndmask_b32 v0, -1, v62, s[44:45]
    buffer_load_dwordx3 v[28:30], v0, s[12:15], 0 offen
    s_and_b64 s[44:45], s[44:45], s[66:67]
    s_mov_b64 s[66:67], -1
    v_add_u32 v62, 48, v62
    v_subrev_u32 v63, 48, v63
    s_waitcnt vmcnt(0)
    v_lshlrev_b32 v52, 16, v29
    v_and_b32 v56, 0xffff0000, v29
    v_mul_f32 v52, 0.15915494, v52
    v_mul_f32 v56, 0.15915494, v56
    v_fract_f32 v52, v52
    v_fract_f32 v56, v56
    v_cos_f32 v52, v52
    v_cos_f32 v56, v56
    v_fma_f32 v0, v52, v52, -0.5
    v_fma_f32 v1, v56, v56, -0.5
    v_cvt_pk_bf16_f32 v52, v52, v0
    v_cvt_pk_bf16_f32 v56, v56, v1
    s_nop 1
K2_GINS:
    s_mov_b64 s[40:41], s[44:45]
    s_mov_b64 s[42:43], s[46:47]
    v_lshrrev_b32 v54, 24, v28
    v_lshl_add_u32 v55, v54, 2, s72
    v_lshrrev_b32 v58, 24, v30
    v_lshl_add_u32 v59, v58, 2, s72
    s_mov_b64 exec, s[40:41]
    ds_add_rtn_u32 v55, v55, v64
    s_mov_b64 exec, s[42:43]
    ds_add_rtn_u32 v59, v59, v64
    s_mov_b64 exec, -1
    v_perm_b32 v53, v28, v28, s33
    v_perm_b32 v57, v30, v30, s33
    s_waitcnt lgkmcnt(0)
    s_mov_b64 exec, s[40:41]
    v_cmp_gt_u32 vcc, s26, v55
    v_mad_u32_u24 v55, v54, s31, v55
    s_andn2_b64 s[44:45], s[40:41], vcc
    s_mov_b64 exec, vcc
    ds_write_b64 v55, v[52:53]
    s_mov_b64 exec, s[42:43]
    v_cmp_gt_u32 vcc, s26, v59
    v_mad_u32_u24 v59, v58, s31, v59
    s_andn2_b64 s[46:47], s[42:43], vcc
    s_mov_b64 exec, vcc
    ds_write_b64 v59, v[56:57]
    s_mov_b64 exec, -1
    s_or_b64 s[64:65], s[44:45], s[46:47]
    s_cselect_b32 s38, 1, 0
    s_cmp_lt_u32 s28, 6
    s_cselect_b32 s38, 1, s38
    v_mov_b32 v0, s38
    v_mov_b32 v1, s27
    s_mov_b64 exec, 1
    ds_or_b32 v1, v0 offset:2056
    s_mov_b64 exec, -1
    s_waitcnt lgkmcnt(0)
    s_barrier
    ds_read_b32 v20, v1 offset:2056
    s_xor_b32 s27, s27, 4
    v_mov_b32 v21, s27
    ds_write_b32 v21, v67 offset:2056
    v_and_b32 v0, 15, v65
    s_add_u32 s38, s72, s25
    v_lshl_add_u32 v66, v0, 6, s38
    ds_read_b32 v43, v66 offset:0
    s_waitcnt lgkmcnt(0)
    v_readfirstlane_b32 s35, v20
    v_cmp_gt_u32 vcc, s36, v0
    v_subrev_u32 v43, s73, v43
    v_mov_b32 v1, s73
    v_min_u32 v43, 0x100, v43
    v_lshlrev_b32 v43, 2, v43
    v_cndmask_b32 v43, 0, v43, vcc
    s_and_b64 exec, vcc, 0xffff
    ds_write_b32 v66, v1 offset:0
    s_mov_b64 exec, -1
    v_cmp_lt_u32 s[64:65], 0, v43
    s_nop 0
    s_bitcmp1_b32 s64, 0
    s_cbranch_scc0 SK_90
    ds_read_b32 v51, v35 offset:4
    ds_read_b64_tr_b16 v[24:25], v39 offset:0
    ds_read_b64_tr_b16 v[26:27], v39 offset:128
    s_waitcnt lgkmcnt(0)
    s_mov_b32 m0, s74
    v_lshrrev_b32 v51, 8, v51
    v_sub_u32_dpp v1, v43, v31 row_newbcast:0 row_mask:0xf bank_mask:0xf
    v_bfi_b32 v51, s32, v51, v1
    buffer_load_dwordx4 v51, s[8:11], 0 offen  lds
    v_and_b32_dpp v4, v24, v47 quad_perm:[2,2,2,2] row_mask:0xf bank_mask:0xf
    v_and_b32_dpp v5, v25, v47 quad_perm:[2,2,2,2] row_mask:0xf bank_mask:0xf
    v_and_b32_dpp v6, v26, v47 quad_perm:[2,2,2,2] row_mask:0xf bank_mask:0xf
    v_and_b32_dpp v7, v27, v47 quad_perm:[2,2,2,2] row_mask:0xf bank_mask:0xf
    v_perm_b32 v4, v3, v2, v4
    v_perm_b32 v5, v3, v2, v5
    v_perm_b32 v6, v3, v2, v6
    v_perm_b32 v7, v3, v2, v7
    v_and_b32_dpp v4, v24, v4 quad_perm:[0,1,0,1] row_mask:0xf bank_mask:0xf
    v_and_b32_dpp v5, v25, v5 quad_perm:[0,1,0,1] row_mask:0xf bank_mask:0xf
    v_and_b32_dpp v6, v26, v6 quad_perm:[0,1,0,1] row_mask:0xf bank_mask:0xf
    v_and_b32_dpp v7, v27, v7 quad_perm:[0,1,0,1] row_mask:0xf bank_mask:0xf
    s_waitcnt vmcnt(0)
    ds_read_b64_tr_b16 v[20:21], v48
    ds_read_b64_tr_b16 v[22:23], v48 offset:512
    s_waitcnt lgkmcnt(0)
    v_mfma_f32_16x16x32_bf16 v[76:79], v[20:23], v[4:7], v[76:79]
    s_nop 7
SK_90:
    s_bitcmp1_b32 s64, 1
    s_cbranch_scc0 SK_91
    ds_read_b32 v51, v35 offset:4228
    ds_read_b64_tr_b16 v[24:25], v39 offset:4224
    ds_read_b64_tr_b16 v[26:27], v39 offset:4352
    s_waitcnt lgkmcnt(0)
    s_mov_b32 m0, s74
    v_lshrrev_b32 v51, 8, v51
    v_sub_u32_dpp v1, v43, v31 row_newbcast:1 row_mask:0xf bank_mask:0xf
    v_bfi_b32 v51, s32, v51, v1
    buffer_load_dwordx4 v51, s[8:11], 0 offen  lds
    v_and_b32_dpp v4, v24, v47 quad_perm:[2,2,2,2] row_mask:0xf bank_mask:0xf
    v_and_b32_dpp v5, v25, v47 quad_perm:[2,2,2,2] row_mask:0xf bank_mask:0xf
    v_and_b32_dpp v6, v26, v47 quad_perm:[2,2,2,2] row_mask:0xf bank_mask:0xf
    v_and_b32_dpp v7, v27, v47 quad_perm:[2,2,2,2] row_mask:0xf bank_mask:0xf
    v_perm_b32 v4, v3, v2, v4
    v_perm_b32 v5, v3, v2, v5
    v_perm_b32 v6, v3, v2, v6
    v_perm_b32 v7, v3, v2, v7
    v_and_b32_dpp v4, v24, v4 quad_perm:[0,1,0,1] row_mask:0xf bank_mask:0xf
    v_and_b32_dpp v5, v25, v5 quad_perm:[0,1,0,1] row_mask:0xf bank_mask:0xf
    v_and_b32_dpp v6, v26, v6 quad_perm:[0,1,0,1] row_mask:0xf bank_mask:0xf
    v_and_b32_dpp v7, v27, v7 quad_perm:[0,1,0,1] row_mask:0xf bank_mask:0xf
    s_waitcnt vmcnt(0)
    ds_read_b64_tr_b16 v[20:21], v48
    ds_read_b64_tr_b16 v[22:23], v48 offset:512
    s_waitcnt lgkmcnt(0)
    v_mfma_f32_16x16x32_bf16 v[80:83], v[20:23], v[4:7], v[80:83]
    s_nop 7
SK_91:
    s_bitcmp1_b32 s64, 2
    s_cbranch_scc0 SK_92
    ds_read_b32 v51, v35 offset:8452
    ds_read_b64_tr_b16 v[24:25], v39 offset:8448
    ds_read_b64_tr_b16 v[26:27], v39 offset:8576
    s_waitcnt lgkmcnt(0)
    s_mov_b32 m0, s74
    v_lshrrev_b32 v51, 8, v51
    v_sub_u32_dpp v1, v43, v31 row_newbcast:2 row_mask:0xf bank_mask:0xf
    v_bfi_b32 v51, s32, v51, v1
    buffer_load_dwordx4 v51, s[8:11], 0 offen  lds
    v_and_b32_dpp v4, v24, v47 quad_perm:[2,2,2,2] row_mask:0xf bank_mask:0xf
    v_and_b32_dpp v5, v25, v47 quad_perm:[2,2,2,2] row_mask:0xf bank_mask:0xf
    v_and_b32_dpp v6, v26, v47 quad_perm:[2,2,2,2] row_mask:0xf bank_mask:0xf
    v_and_b32_dpp v7, v27, v47 quad_perm:[2,2,2,2] row_mask:0xf bank_mask:0xf
    v_perm_b32 v4, v3, v2, v4
    v_perm_b32 v5, v3, v2, v5
    v_perm_b32 v6, v3, v2, v6
    v_perm_b32 v7, v3, v2, v7
    v_and_b32_dpp v4, v24, v4 quad_perm:[0,1,0,1] row_mask:0xf bank_mask:0xf
    v_and_b32_dpp v5, v25, v5 quad_perm:[0,1,0,1] row_mask:0xf bank_mask:0xf
    v_and_b32_dpp v6, v26, v6 quad_perm:[0,1,0,1] row_mask:0xf bank_mask:0xf
    v_and_b32_dpp v7, v27, v7 quad_perm:[0,1,0,1] row_mask:0xf bank_mask:0xf
    s_waitcnt vmcnt(0)
    ds_read_b64_tr_b16 v[20:21], v48
    ds_read_b64_tr_b16 v[22:23], v48 offset:512
    s_waitcnt lgkmcnt(0)
    v_mfma_f32_16x16x32_bf16 v[84:87], v[20:23], v[4:7], v[84:87]
    s_nop 7
SK_92:
    s_bitcmp1_b32 s64, 3
    s_cbranch_scc0 SK_93
    ds_read_b32 v51, v35 offset:12676
    ds_read_b64_tr_b16 v[24:25], v39 offset:12672
    ds_read_b64_tr_b16 v[26:27], v39 offset:12800
    s_waitcnt lgkmcnt(0)
    s_mov_b32 m0, s74
    v_lshrrev_b32 v51, 8, v51
    v_sub_u32_dpp v1, v43, v31 row_newbcast:3 row_mask:0xf bank_mask:0xf
    v_bfi_b32 v51, s32, v51, v1
    buffer_load_dwordx4 v51, s[8:11], 0 offen  lds
    v_and_b32_dpp v4, v24, v47 quad_perm:[2,2,2,2] row_mask:0xf bank_mask:0xf
    v_and_b32_dpp v5, v25, v47 quad_perm:[2,2,2,2] row_mask:0xf bank_mask:0xf
    v_and_b32_dpp v6, v26, v47 quad_perm:[2,2,2,2] row_mask:0xf bank_mask:0xf
    v_and_b32_dpp v7, v27, v47 quad_perm:[2,2,2,2] row_mask:0xf bank_mask:0xf
    v_perm_b32 v4, v3, v2, v4
    v_perm_b32 v5, v3, v2, v5
    v_perm_b32 v6, v3, v2, v6
    v_perm_b32 v7, v3, v2, v7
    v_and_b32_dpp v4, v24, v4 quad_perm:[0,1,0,1] row_mask:0xf bank_mask:0xf
    v_and_b32_dpp v5, v25, v5 quad_perm:[0,1,0,1] row_mask:0xf bank_mask:0xf
    v_and_b32_dpp v6, v26, v6 quad_perm:[0,1,0,1] row_mask:0xf bank_mask:0xf
    v_and_b32_dpp v7, v27, v7 quad_perm:[0,1,0,1] row_mask:0xf bank_mask:0xf
    s_waitcnt vmcnt(0)
    ds_read_b64_tr_b16 v[20:21], v48
    ds_read_b64_tr_b16 v[22:23], v48 offset:512
    s_waitcnt lgkmcnt(0)
    v_mfma_f32_16x16x32_bf16 v[88:91], v[20:23], v[4:7], v[88:91]
    s_nop 7
SK_93:
    s_bitcmp1_b32 s64, 4
    s_cbranch_scc0 SK_94
    ds_read_b32 v51, v35 offset:16900
    ds_read_b64_tr_b16 v[24:25], v39 offset:16896
    ds_read_b64_tr_b16 v[26:27], v39 offset:17024
    s_waitcnt lgkmcnt(0)
    s_mov_b32 m0, s74
    v_lshrrev_b32 v51, 8, v51
    v_sub_u32_dpp v1, v43, v31 row_newbcast:4 row_mask:0xf bank_mask:0xf
    v_bfi_b32 v51, s32, v51, v1
    buffer_load_dwordx4 v51, s[8:11], 0 offen  lds
    v_and_b32_dpp v4, v24, v47 quad_perm:[2,2,2,2] row_mask:0xf bank_mask:0xf
    v_and_b32_dpp v5, v25, v47 quad_perm:[2,2,2,2] row_mask:0xf bank_mask:0xf
    v_and_b32_dpp v6, v26, v47 quad_perm:[2,2,2,2] row_mask:0xf bank_mask:0xf
    v_and_b32_dpp v7, v27, v47 quad_perm:[2,2,2,2] row_mask:0xf bank_mask:0xf
    v_perm_b32 v4, v3, v2, v4
    v_perm_b32 v5, v3, v2, v5
    v_perm_b32 v6, v3, v2, v6
    v_perm_b32 v7, v3, v2, v7
    v_and_b32_dpp v4, v24, v4 quad_perm:[0,1,0,1] row_mask:0xf bank_mask:0xf
    v_and_b32_dpp v5, v25, v5 quad_perm:[0,1,0,1] row_mask:0xf bank_mask:0xf
    v_and_b32_dpp v6, v26, v6 quad_perm:[0,1,0,1] row_mask:0xf bank_mask:0xf
    v_and_b32_dpp v7, v27, v7 quad_perm:[0,1,0,1] row_mask:0xf bank_mask:0xf
    s_waitcnt vmcnt(0)
    ds_read_b64_tr_b16 v[20:21], v48
    ds_read_b64_tr_b16 v[22:23], v48 offset:512
    s_waitcnt lgkmcnt(0)
    v_mfma_f32_16x16x32_bf16 v[92:95], v[20:23], v[4:7], v[92:95]
    s_nop 7
SK_94:
    s_bitcmp1_b32 s64, 5
    s_cbranch_scc0 SK_95
    ds_read_b32 v51, v35 offset:21124
    ds_read_b64_tr_b16 v[24:25], v39 offset:21120
    ds_read_b64_tr_b16 v[26:27], v39 offset:21248
    s_waitcnt lgkmcnt(0)
    s_mov_b32 m0, s74
    v_lshrrev_b32 v51, 8, v51
    v_sub_u32_dpp v1, v43, v31 row_newbcast:5 row_mask:0xf bank_mask:0xf
    v_bfi_b32 v51, s32, v51, v1
    buffer_load_dwordx4 v51, s[8:11], 0 offen  lds
    v_and_b32_dpp v4, v24, v47 quad_perm:[2,2,2,2] row_mask:0xf bank_mask:0xf
    v_and_b32_dpp v5, v25, v47 quad_perm:[2,2,2,2] row_mask:0xf bank_mask:0xf
    v_and_b32_dpp v6, v26, v47 quad_perm:[2,2,2,2] row_mask:0xf bank_mask:0xf
    v_and_b32_dpp v7, v27, v47 quad_perm:[2,2,2,2] row_mask:0xf bank_mask:0xf
    v_perm_b32 v4, v3, v2, v4
    v_perm_b32 v5, v3, v2, v5
    v_perm_b32 v6, v3, v2, v6
    v_perm_b32 v7, v3, v2, v7
    v_and_b32_dpp v4, v24, v4 quad_perm:[0,1,0,1] row_mask:0xf bank_mask:0xf
    v_and_b32_dpp v5, v25, v5 quad_perm:[0,1,0,1] row_mask:0xf bank_mask:0xf
    v_and_b32_dpp v6, v26, v6 quad_perm:[0,1,0,1] row_mask:0xf bank_mask:0xf
    v_and_b32_dpp v7, v27, v7 quad_perm:[0,1,0,1] row_mask:0xf bank_mask:0xf
    s_waitcnt vmcnt(0)
    ds_read_b64_tr_b16 v[20:21], v48
    ds_read_b64_tr_b16 v[22:23], v48 offset:512
    s_waitcnt lgkmcnt(0)
    v_mfma_f32_16x16x32_bf16 v[96:99], v[20:23], v[4:7], v[96:99]
    s_nop 7
SK_95:
    s_bitcmp1_b32 s64, 6
    s_cbranch_scc0 SK_96
    ds_read_b32 v51, v35 offset:25348
    ds_read_b64_tr_b16 v[24:25], v39 offset:25344
    ds_read_b64_tr_b16 v[26:27], v39 offset:25472
    s_waitcnt lgkmcnt(0)
    s_mov_b32 m0, s74
    v_lshrrev_b32 v51, 8, v51
    v_sub_u32_dpp v1, v43, v31 row_newbcast:6 row_mask:0xf bank_mask:0xf
    v_bfi_b32 v51, s32, v51, v1
    buffer_load_dwordx4 v51, s[8:11], 0 offen  lds
    v_and_b32_dpp v4, v24, v47 quad_perm:[2,2,2,2] row_mask:0xf bank_mask:0xf
    v_and_b32_dpp v5, v25, v47 quad_perm:[2,2,2,2] row_mask:0xf bank_mask:0xf
    v_and_b32_dpp v6, v26, v47 quad_perm:[2,2,2,2] row_mask:0xf bank_mask:0xf
    v_and_b32_dpp v7, v27, v47 quad_perm:[2,2,2,2] row_mask:0xf bank_mask:0xf
    v_perm_b32 v4, v3, v2, v4
    v_perm_b32 v5, v3, v2, v5
    v_perm_b32 v6, v3, v2, v6
    v_perm_b32 v7, v3, v2, v7
    v_and_b32_dpp v4, v24, v4 quad_perm:[0,1,0,1] row_mask:0xf bank_mask:0xf
    v_and_b32_dpp v5, v25, v5 quad_perm:[0,1,0,1] row_mask:0xf bank_mask:0xf
    v_and_b32_dpp v6, v26, v6 quad_perm:[0,1,0,1] row_mask:0xf bank_mask:0xf
    v_and_b32_dpp v7, v27, v7 quad_perm:[0,1,0,1] row_mask:0xf bank_mask:0xf
    s_waitcnt vmcnt(0)
    ds_read_b64_tr_b16 v[20:21], v48
    ds_read_b64_tr_b16 v[22:23], v48 offset:512
    s_waitcnt lgkmcnt(0)
    v_mfma_f32_16x16x32_bf16 v[100:103], v[20:23], v[4:7], v[100:103]
    s_nop 7
SK_96:
    s_bitcmp1_b32 s64, 7
    s_cbranch_scc0 SK_97
    ds_read_b32 v51, v35 offset:29572
    ds_read_b64_tr_b16 v[24:25], v39 offset:29568
    ds_read_b64_tr_b16 v[26:27], v39 offset:29696
    s_waitcnt lgkmcnt(0)
    s_mov_b32 m0, s74
    v_lshrrev_b32 v51, 8, v51
    v_sub_u32_dpp v1, v43, v31 row_newbcast:7 row_mask:0xf bank_mask:0xf
    v_bfi_b32 v51, s32, v51, v1
    buffer_load_dwordx4 v51, s[8:11], 0 offen  lds
    v_and_b32_dpp v4, v24, v47 quad_perm:[2,2,2,2] row_mask:0xf bank_mask:0xf
    v_and_b32_dpp v5, v25, v47 quad_perm:[2,2,2,2] row_mask:0xf bank_mask:0xf
    v_and_b32_dpp v6, v26, v47 quad_perm:[2,2,2,2] row_mask:0xf bank_mask:0xf
    v_and_b32_dpp v7, v27, v47 quad_perm:[2,2,2,2] row_mask:0xf bank_mask:0xf
    v_perm_b32 v4, v3, v2, v4
    v_perm_b32 v5, v3, v2, v5
    v_perm_b32 v6, v3, v2, v6
    v_perm_b32 v7, v3, v2, v7
    v_and_b32_dpp v4, v24, v4 quad_perm:[0,1,0,1] row_mask:0xf bank_mask:0xf
    v_and_b32_dpp v5, v25, v5 quad_perm:[0,1,0,1] row_mask:0xf bank_mask:0xf
    v_and_b32_dpp v6, v26, v6 quad_perm:[0,1,0,1] row_mask:0xf bank_mask:0xf
    v_and_b32_dpp v7, v27, v7 quad_perm:[0,1,0,1] row_mask:0xf bank_mask:0xf
    s_waitcnt vmcnt(0)
    ds_read_b64_tr_b16 v[20:21], v48
    ds_read_b64_tr_b16 v[22:23], v48 offset:512
    s_waitcnt lgkmcnt(0)
    v_mfma_f32_16x16x32_bf16 v[104:107], v[20:23], v[4:7], v[104:107]
    s_nop 7
SK_97:
    s_bitcmp1_b32 s64, 8
    s_cbranch_scc0 SK_98
    ds_read_b32 v51, v35 offset:33796
    ds_read_b64_tr_b16 v[24:25], v39 offset:33792
    ds_read_b64_tr_b16 v[26:27], v39 offset:33920
    s_waitcnt lgkmcnt(0)
    s_mov_b32 m0, s74
    v_lshrrev_b32 v51, 8, v51
    v_sub_u32_dpp v1, v43, v31 row_newbcast:8 row_mask:0xf bank_mask:0xf
    v_bfi_b32 v51, s32, v51, v1
    buffer_load_dwordx4 v51, s[8:11], 0 offen  lds
    v_and_b32_dpp v4, v24, v47 quad_perm:[2,2,2,2] row_mask:0xf bank_mask:0xf
    v_and_b32_dpp v5, v25, v47 quad_perm:[2,2,2,2] row_mask:0xf bank_mask:0xf
    v_and_b32_dpp v6, v26, v47 quad_perm:[2,2,2,2] row_mask:0xf bank_mask:0xf
    v_and_b32_dpp v7, v27, v47 quad_perm:[2,2,2,2] row_mask:0xf bank_mask:0xf
    v_perm_b32 v4, v3, v2, v4
    v_perm_b32 v5, v3, v2, v5
    v_perm_b32 v6, v3, v2, v6
    v_perm_b32 v7, v3, v2, v7
    v_and_b32_dpp v4, v24, v4 quad_perm:[0,1,0,1] row_mask:0xf bank_mask:0xf
    v_and_b32_dpp v5, v25, v5 quad_perm:[0,1,0,1] row_mask:0xf bank_mask:0xf
    v_and_b32_dpp v6, v26, v6 quad_perm:[0,1,0,1] row_mask:0xf bank_mask:0xf
    v_and_b32_dpp v7, v27, v7 quad_perm:[0,1,0,1] row_mask:0xf bank_mask:0xf
    s_waitcnt vmcnt(0)
    ds_read_b64_tr_b16 v[20:21], v48
    ds_read_b64_tr_b16 v[22:23], v48 offset:512
    s_waitcnt lgkmcnt(0)
    v_mfma_f32_16x16x32_bf16 v[108:111], v[20:23], v[4:7], v[108:111]
    s_nop 7
SK_98:
    s_bitcmp1_b32 s64, 9
    s_cbranch_scc0 SK_99
    ds_read_b32 v51, v35 offset:38020
    ds_read_b64_tr_b16 v[24:25], v39 offset:38016
    ds_read_b64_tr_b16 v[26:27], v39 offset:38144
    s_waitcnt lgkmcnt(0)
    s_mov_b32 m0, s74
    v_lshrrev_b32 v51, 8, v51
    v_sub_u32_dpp v1, v43, v31 row_newbcast:9 row_mask:0xf bank_mask:0xf
    v_bfi_b32 v51, s32, v51, v1
    buffer_load_dwordx4 v51, s[8:11], 0 offen  lds
    v_and_b32_dpp v4, v24, v47 quad_perm:[2,2,2,2] row_mask:0xf bank_mask:0xf
    v_and_b32_dpp v5, v25, v47 quad_perm:[2,2,2,2] row_mask:0xf bank_mask:0xf
    v_and_b32_dpp v6, v26, v47 quad_perm:[2,2,2,2] row_mask:0xf bank_mask:0xf
    v_and_b32_dpp v7, v27, v47 quad_perm:[2,2,2,2] row_mask:0xf bank_mask:0xf
    v_perm_b32 v4, v3, v2, v4
    v_perm_b32 v5, v3, v2, v5
    v_perm_b32 v6, v3, v2, v6
    v_perm_b32 v7, v3, v2, v7
    v_and_b32_dpp v4, v24, v4 quad_perm:[0,1,0,1] row_mask:0xf bank_mask:0xf
    v_and_b32_dpp v5, v25, v5 quad_perm:[0,1,0,1] row_mask:0xf bank_mask:0xf
    v_and_b32_dpp v6, v26, v6 quad_perm:[0,1,0,1] row_mask:0xf bank_mask:0xf
    v_and_b32_dpp v7, v27, v7 quad_perm:[0,1,0,1] row_mask:0xf bank_mask:0xf
    s_waitcnt vmcnt(0)
    ds_read_b64_tr_b16 v[20:21], v48
    ds_read_b64_tr_b16 v[22:23], v48 offset:512
    s_waitcnt lgkmcnt(0)
    v_mfma_f32_16x16x32_bf16 v[112:115], v[20:23], v[4:7], v[112:115]
    s_nop 7
SK_99:
    s_bitcmp1_b32 s64, 10
    s_cbranch_scc0 SK_100
    ds_read_b32 v51, v35 offset:42244
    ds_read_b64_tr_b16 v[24:25], v39 offset:42240
    ds_read_b64_tr_b16 v[26:27], v39 offset:42368
    s_waitcnt lgkmcnt(0)
    s_mov_b32 m0, s74
    v_lshrrev_b32 v51, 8, v51
    v_sub_u32_dpp v1, v43, v31 row_newbcast:10 row_mask:0xf bank_mask:0xf
    v_bfi_b32 v51, s32, v51, v1
    buffer_load_dwordx4 v51, s[8:11], 0 offen  lds
    v_and_b32_dpp v4, v24, v47 quad_perm:[2,2,2,2] row_mask:0xf bank_mask:0xf
    v_and_b32_dpp v5, v25, v47 quad_perm:[2,2,2,2] row_mask:0xf bank_mask:0xf
    v_and_b32_dpp v6, v26, v47 quad_perm:[2,2,2,2] row_mask:0xf bank_mask:0xf
    v_and_b32_dpp v7, v27, v47 quad_perm:[2,2,2,2] row_mask:0xf bank_mask:0xf
    v_perm_b32 v4, v3, v2, v4
    v_perm_b32 v5, v3, v2, v5
    v_perm_b32 v6, v3, v2, v6
    v_perm_b32 v7, v3, v2, v7
    v_and_b32_dpp v4, v24, v4 quad_perm:[0,1,0,1] row_mask:0xf bank_mask:0xf
    v_and_b32_dpp v5, v25, v5 quad_perm:[0,1,0,1] row_mask:0xf bank_mask:0xf
    v_and_b32_dpp v6, v26, v6 quad_perm:[0,1,0,1] row_mask:0xf bank_mask:0xf
    v_and_b32_dpp v7, v27, v7 quad_perm:[0,1,0,1] row_mask:0xf bank_mask:0xf
    s_waitcnt vmcnt(0)
    ds_read_b64_tr_b16 v[20:21], v48
    ds_read_b64_tr_b16 v[22:23], v48 offset:512
    s_waitcnt lgkmcnt(0)
    v_mfma_f32_16x16x32_bf16 v[116:119], v[20:23], v[4:7], v[116:119]
    s_nop 7
SK_100:
    s_bitcmp1_b32 s64, 11
    s_cbranch_scc0 SK_101
    ds_read_b32 v51, v35 offset:46468
    ds_read_b64_tr_b16 v[24:25], v39 offset:46464
    ds_read_b64_tr_b16 v[26:27], v39 offset:46592
    s_waitcnt lgkmcnt(0)
    s_mov_b32 m0, s74
    v_lshrrev_b32 v51, 8, v51
    v_sub_u32_dpp v1, v43, v31 row_newbcast:11 row_mask:0xf bank_mask:0xf
    v_bfi_b32 v51, s32, v51, v1
    buffer_load_dwordx4 v51, s[8:11], 0 offen  lds
    v_and_b32_dpp v4, v24, v47 quad_perm:[2,2,2,2] row_mask:0xf bank_mask:0xf
    v_and_b32_dpp v5, v25, v47 quad_perm:[2,2,2,2] row_mask:0xf bank_mask:0xf
    v_and_b32_dpp v6, v26, v47 quad_perm:[2,2,2,2] row_mask:0xf bank_mask:0xf
    v_and_b32_dpp v7, v27, v47 quad_perm:[2,2,2,2] row_mask:0xf bank_mask:0xf
    v_perm_b32 v4, v3, v2, v4
    v_perm_b32 v5, v3, v2, v5
    v_perm_b32 v6, v3, v2, v6
    v_perm_b32 v7, v3, v2, v7
    v_and_b32_dpp v4, v24, v4 quad_perm:[0,1,0,1] row_mask:0xf bank_mask:0xf
    v_and_b32_dpp v5, v25, v5 quad_perm:[0,1,0,1] row_mask:0xf bank_mask:0xf
    v_and_b32_dpp v6, v26, v6 quad_perm:[0,1,0,1] row_mask:0xf bank_mask:0xf
    v_and_b32_dpp v7, v27, v7 quad_perm:[0,1,0,1] row_mask:0xf bank_mask:0xf
    s_waitcnt vmcnt(0)
    ds_read_b64_tr_b16 v[20:21], v48
    ds_read_b64_tr_b16 v[22:23], v48 offset:512
    s_waitcnt lgkmcnt(0)
    v_mfma_f32_16x16x32_bf16 v[120:123], v[20:23], v[4:7], v[120:123]
    s_nop 7
SK_101:
    s_bitcmp1_b32 s64, 12
    s_cbranch_scc0 SK_102
    ds_read_b32 v51, v35 offset:50692
    ds_read_b64_tr_b16 v[24:25], v39 offset:50688
    ds_read_b64_tr_b16 v[26:27], v39 offset:50816
    s_waitcnt lgkmcnt(0)
    s_mov_b32 m0, s74
    v_lshrrev_b32 v51, 8, v51
    v_sub_u32_dpp v1, v43, v31 row_newbcast:12 row_mask:0xf bank_mask:0xf
    v_bfi_b32 v51, s32, v51, v1
    buffer_load_dwordx4 v51, s[8:11], 0 offen  lds
    v_and_b32_dpp v4, v24, v47 quad_perm:[2,2,2,2] row_mask:0xf bank_mask:0xf
    v_and_b32_dpp v5, v25, v47 quad_perm:[2,2,2,2] row_mask:0xf bank_mask:0xf
    v_and_b32_dpp v6, v26, v47 quad_perm:[2,2,2,2] row_mask:0xf bank_mask:0xf
    v_and_b32_dpp v7, v27, v47 quad_perm:[2,2,2,2] row_mask:0xf bank_mask:0xf
    v_perm_b32 v4, v3, v2, v4
    v_perm_b32 v5, v3, v2, v5
    v_perm_b32 v6, v3, v2, v6
    v_perm_b32 v7, v3, v2, v7
    v_and_b32_dpp v4, v24, v4 quad_perm:[0,1,0,1] row_mask:0xf bank_mask:0xf
    v_and_b32_dpp v5, v25, v5 quad_perm:[0,1,0,1] row_mask:0xf bank_mask:0xf
    v_and_b32_dpp v6, v26, v6 quad_perm:[0,1,0,1] row_mask:0xf bank_mask:0xf
    v_and_b32_dpp v7, v27, v7 quad_perm:[0,1,0,1] row_mask:0xf bank_mask:0xf
    s_waitcnt vmcnt(0)
    ds_read_b64_tr_b16 v[20:21], v48
    ds_read_b64_tr_b16 v[22:23], v48 offset:512
    s_waitcnt lgkmcnt(0)
    v_mfma_f32_16x16x32_bf16 v[124:127], v[20:23], v[4:7], v[124:127]
    s_nop 7
SK_102:
    s_waitcnt lgkmcnt(0)
    s_barrier
    s_cmp_lg_u32 s35, 0
    s_nop 4
    s_cbranch_scc1 K2_GTOP
    s_mul_i32 s38, s3, 50176
    s_lshl_b32 s39, s24, 8
    s_add_u32 s38, s38, s39
    v_lshrrev_b32 v0, 4, v65
    v_and_b32 v1, 15, v65
    v_lshlrev_b32 v62, 12, v0
    v_lshl_add_u32 v62, v1, 4, v62
    v_add_u32 v62, s38, v62
    s_mul_i32 s70, s24, 3072
    s_min_u32 s38, s24, 4
    s_lshl_b32 s38, s38, 8
    s_add_u32 s70, s70, s38
    s_add_u32 s70, s70, 59968
    v_lshl_add_u32 v61, v65, 4, s70
    v_lshl_add_u32 v60, v0, 3, s70
    v_and_b32 v0, 14, v65
    v_lshl_add_u32 v60, v0, 4, v60
    v_and_b32 v0, 1, v65
    v_lshl_add_u32 v60, v0, 8, v60
    v_add_u32 v0, 32768, v62
    s_add_u32 m0, s70, 2048
    s_nop 0
    buffer_load_dwordx4 v0, s[8:11], 0 offen lds
    v_add_u32 v0, 16384, v62
    s_add_u32 m0, s70, 1024
    s_nop 0
    buffer_load_dwordx4 v0, s[8:11], 0 offen lds
    v_add_u32 v0, 0, v62
    s_add_u32 m0, s70, 0
    s_nop 0
    buffer_load_dwordx4 v0, s[8:11], 0 offen lds
    v_add_u32 v0, 49152, v62
    s_add_u32 m0, s70, 3072
    s_cmp_lt_u32 s24, 4
    s_cselect_b32 m0, m0, s70
    s_cselect_b32 s38, 0, 49152
    v_subrev_u32 v0, s38, v0
    s_mov_b64 exec, 0xffff
    buffer_load_dwordx4 v0, s[8:11], 0 offen lds
    s_mov_b64 exec, -1
    s_branch K2_EPI
K2_PAIR:
    v_lshlrev_b32 v51, 3, v65
    s_mov_b32 vcc_lo, 0x55555555
    s_mov_b32 vcc_hi, 0x55555555
    ds_read_b64 v[0:1], v51 offset:4160
    ds_read_b64 v[24:25], v51 offset:2624
    ds_read_b64 v[26:27], v51 offset:3136
    ds_read_b64 v[44:45], v51 offset:3648
    ds_read_b64 v[32:33], v51 offset:4672
    ds_read_b64 v[28:29], v38
    v_cndmask_b32_dpp v54, v56, v52, vcc quad_perm:[1,0,3,2] row_mask:0xf bank_mask:0xf
    v_cndmask_b32_dpp v55, v57, v53, vcc quad_perm:[1,0,3,2] row_mask:0xf bank_mask:0xf
    s_not_b64 vcc, vcc
    v_cndmask_b32_dpp v58, v52, v56, vcc quad_perm:[1,0,3,2] row_mask:0xf bank_mask:0xf
    v_cndmask_b32_dpp v59, v53, v57, vcc quad_perm:[1,0,3,2] row_mask:0xf bank_mask:0xf
    s_waitcnt lgkmcnt(0)
    v_mfma_f32_16x16x16_bf16 v[20:23], v[24:25], v[36:37], 0
    v_mfma_f32_16x16x16_bf16 v[52:55], v[0:1], v[54:55], 0
    v_mfma_f32_16x16x16_bf16 v[56:59], v[0:1], v[58:59], 0
    v_mfma_f32_16x16x16_bf16 v[24:27], v[26:27], v[36:37], 0
    s_nop 5
    v_mul_f32 v52, v52, v20
    v_mul_f32 v53, v53, v21
    v_mul_f32 v54, v54, v22
    v_mul_f32 v55, v55, v23
    v_fmac_f32 v52, v56, v24
    v_fmac_f32 v53, v57, v25
    v_fmac_f32 v54, v58, v26
    v_fmac_f32 v55, v59, v27
    v_cvt_pk_bf16_f32 v52, v52, v53
    v_cvt_pk_bf16_f32 v53, v54, v55
    v_mfma_f32_16x16x16_bf16 v[56:59], v[44:45], v[36:37], 0
    s_nop 0
    v_mfma_f32_16x16x16_bf16 v[52:55], v[32:33], v[52:53], 0
    v_lshlrev_b32 v20, 16, v28
    v_and_b32 v21, 0xffff0000, v28
    v_lshlrev_b32 v22, 16, v29
    v_and_b32 v23, 0xffff0000, v29
    s_nop 3
    v_fmac_f32 v20, v52, v56
    v_fmac_f32 v21, v53, v57
    v_fmac_f32 v22, v54, v58
    v_fmac_f32 v23, v55, v59
    v_cvt_pk_bf16_f32 v28, v20, v21
    v_cvt_pk_bf16_f32 v29, v22, v23
    s_mov_b64 exec, s[64:65]
    ds_write_b64 v38, v[28:29]
    s_mov_b64 exec, -1
    s_nop 0
    s_setpc_b64 s[98:99]
RARE_3:
    s_nop 4
    s_bcnt1_i32_b64 s38, s[62:63]
    s_add_u32 s38, s38, s29
    s_cmp_gt_u32 s38, 44
    s_cselect_b32 s30, 1, s30
    s_cbranch_scc1 BACK_4
    s_mov_b64 exec, s[62:63]
    v_mbcnt_lo_u32_b32 v66, s62, 0
    v_mbcnt_hi_u32_b32 v66, s63, v66
    v_add_lshl_u32 v66, v66, s29, 3
    v_add_u32 v66, s34, v66
    s_mov_b32 s29, s38
    ds_write2_b32 v66, v28, v52 offset0:0 offset1:1
    s_nop 1
    s_branch BACK_4
RARE_5:
    s_nop 4
    s_bcnt1_i32_b64 s38, s[62:63]
    s_add_u32 s38, s38, s29
    s_cmp_gt_u32 s38, 44
    s_cselect_b32 s30, 1, s30
    s_cbranch_scc1 BACK_6
    s_mov_b64 exec, s[62:63]
    v_mbcnt_lo_u32_b32 v66, s62, 0
    v_mbcnt_hi_u32_b32 v66, s63, v66
    v_add_lshl_u32 v66, v66, s29, 3
    v_add_u32 v66, s34, v66
    s_mov_b32 s29, s38
    ds_write2_b32 v66, v30, v56 offset0:0 offset1:1
    s_nop 1
    s_branch BACK_6
LONG_7:
    s_nop 7
    v_add_u32 v62, 192, v62
    v_subrev_u32 v63, 192, v63
    s_nop 1
LLOOP_103:
    v_cmp_lt_i32 s[40:41], 0, v63
    v_cmp_lt_i32 s[42:43], 6, v63
    s_nop 0
    v_cndmask_b32 v0, -1, v62, s[40:41]
    buffer_load_dwordx3 v[28:30], v0, s[12:15], 0 offen
    v_add_u32 v62, 48, v62
    v_subrev_u32 v63, 48, v63
    s_waitcnt vmcnt(0)
    v_lshrrev_b32 v54, 24, v28
    v_lshl_add_u32 v55, v54, 2, s72
    v_lshrrev_b32 v58, 24, v30
    v_lshl_add_u32 v59, v58, 2, s72
    s_mov_b64 exec, s[40:41]
    ds_add_rtn_u32 v55, v55, v64
    s_mov_b64 exec, s[42:43]
    ds_add_rtn_u32 v59, v59, v64
    s_mov_b64 exec, -1
    v_lshlrev_b32 v52, 16, v29
    v_and_b32 v56, 0xffff0000, v29
    v_mul_f32 v52, 0.15915494, v52
    v_mul_f32 v56, 0.15915494, v56
    v_fract_f32 v52, v52
    v_fract_f32 v56, v56
    v_cos_f32 v52, v52
    v_cos_f32 v56, v56
    v_fma_f32 v0, v52, v52, -0.5
    v_fma_f32 v1, v56, v56, -0.5
    v_cvt_pk_bf16_f32 v52, v52, v0
    v_cvt_pk_bf16_f32 v56, v56, v1
    v_perm_b32 v53, v28, v28, s33
    v_perm_b32 v57, v30, v30, s33
    s_waitcnt lgkmcnt(0)
    s_mov_b64 exec, s[40:41]
    v_cmp_gt_u32 vcc, s26, v55
    v_mad_u32_u24 v55, v54, s31, v55
    s_andn2_b64 s[62:63], s[40:41], vcc
    s_cbranch_scc1 RARE_104
BACK_105:
    s_mov_b64 exec, vcc
    ds_write_b64 v55, v[52:53]
    s_mov_b64 exec, s[42:43]
    v_cmp_gt_u32 vcc, s26, v59
    v_mad_u32_u24 v59, v58, s31, v59
    s_andn2_b64 s[62:63], s[42:43], vcc
    s_cbranch_scc1 RARE_106
BACK_107:
    s_mov_b64 exec, vcc
    ds_write_b64 v59, v[56:57]
    s_mov_b64 exec, -1
    v_cmp_lt_i32 vcc, 0, v63
    s_cmp_lg_u32 s30, 0
    s_cbranch_scc1 LBACK_8
    s_nop 2
    s_cbranch_vccnz LLOOP_103
    s_branch LBACK_8
RARE_10:
    s_nop 4
    s_bcnt1_i32_b64 s38, s[62:63]
    s_add_u32 s38, s38, s29
    s_cmp_gt_u32 s38, 44
    s_cselect_b32 s30, 1, s30
    s_cbranch_scc1 BACK_11
    s_mov_b64 exec, s[62:63]
    v_mbcnt_lo_u32_b32 v66, s62, 0
    v_mbcnt_hi_u32_b32 v66, s63, v66
    v_add_lshl_u32 v66, v66, s29, 3
    v_add_u32 v66, s34, v66
    s_mov_b32 s29, s38
    ds_write2_b32 v66, v32, v52 offset0:0 offset1:1
    s_nop 1
    s_branch BACK_11
RARE_12:
    s_nop 4
    s_bcnt1_i32_b64 s38, s[62:63]
    s_add_u32 s38, s38, s29
    s_cmp_gt_u32 s38, 44
    s_cselect_b32 s30, 1, s30
    s_cbranch_scc1 BACK_13
    s_mov_b64 exec, s[62:63]
    v_mbcnt_lo_u32_b32 v66, s62, 0
    v_mbcnt_hi_u32_b32 v66, s63, v66
    v_add_lshl_u32 v66, v66, s29, 3
    v_add_u32 v66, s34, v66
    s_mov_b32 s29, s38
    ds_write2_b32 v66, v34, v56 offset0:0 offset1:1
    s_nop 1
    s_branch BACK_13
RARE_15:
    s_nop 4
    s_bcnt1_i32_b64 s38, s[62:63]
    s_add_u32 s38, s38, s29
    s_cmp_gt_u32 s38, 44
    s_cselect_b32 s30, 1, s30
    s_cbranch_scc1 BACK_16
    s_mov_b64 exec, s[62:63]
    v_mbcnt_lo_u32_b32 v66, s62, 0
    v_mbcnt_hi_u32_b32 v66, s63, v66
    v_add_lshl_u32 v66, v66, s29, 3
    v_add_u32 v66, s34, v66
    s_mov_b32 s29, s38
    ds_write2_b32 v66, v36, v52 offset0:0 offset1:1
    s_nop 1
    s_branch BACK_16
RARE_17:
    s_nop 4
    s_bcnt1_i32_b64 s38, s[62:63]
    s_add_u32 s38, s38, s29
    s_cmp_gt_u32 s38, 44
    s_cselect_b32 s30, 1, s30
    s_cbranch_scc1 BACK_18
    s_mov_b64 exec, s[62:63]
    v_mbcnt_lo_u32_b32 v66, s62, 0
    v_mbcnt_hi_u32_b32 v66, s63, v66
    v_add_lshl_u32 v66, v66, s29, 3
    v_add_u32 v66, s34, v66
    s_mov_b32 s29, s38
    ds_write2_b32 v66, v38, v56 offset0:0 offset1:1
    s_nop 1
    s_branch BACK_18
RARE_20:
    s_nop 4
    s_bcnt1_i32_b64 s38, s[62:63]
    s_add_u32 s38, s38, s29
    s_cmp_gt_u32 s38, 44
    s_cselect_b32 s30, 1, s30
    s_cbranch_scc1 BACK_21
    s_mov_b64 exec, s[62:63]
    v_mbcnt_lo_u32_b32 v66, s62, 0
    v_mbcnt_hi_u32_b32 v66, s63, v66
    v_add_lshl_u32 v66, v66, s29, 3
    v_add_u32 v66, s34, v66
    s_mov_b32 s29, s38
    ds_write2_b32 v66, v40, v52 offset0:0 offset1:1
    s_nop 1
    s_branch BACK_21
RARE_22:
    s_nop 4
    s_bcnt1_i32_b64 s38, s[62:63]
    s_add_u32 s38, s38, s29
    s_cmp_gt_u32 s38, 44
    s_cselect_b32 s30, 1, s30
    s_cbranch_scc1 BACK_23
    s_mov_b64 exec, s[62:63]
    v_mbcnt_lo_u32_b32 v66, s62, 0
    v_mbcnt_hi_u32_b32 v66, s63, v66
    v_add_lshl_u32 v66, v66, s29, 3
    v_add_u32 v66, s34, v66
    s_mov_b32 s29, s38
    ds_write2_b32 v66, v42, v56 offset0:0 offset1:1
    s_nop 1
    s_branch BACK_23
POLL_25:
    ds_read_b32 v46, v67 offset:2068
    s_waitcnt lgkmcnt(0)
    v_readfirstlane_b32 s5, v46
    s_nop 0
    s_cmp_ge_u32 s5, s7
    s_cbranch_scc1 PDONE_26
    s_sleep 1
    s_branch POLL_25
SD_31:
    s_nop 4
    v_and_b32 v0, 1, v65
    v_and_b32 v1, 0x2c, v65
    v_lshl_add_u32 v0, v0, 4, v1
    ds_bpermute_b32 v68, v0, v75 offset:0
    ds_bpermute_b32 v70, v0, v75 offset:64
    s_mov_b32 vcc_lo, 0xffff0000
    s_mov_b32 vcc_hi, 0xffff0000
    v_mov_b32 v52, s88
    v_mov_b32 v53, s89
    v_mov_b32 v54, s90
    v_mov_b32 v55, s91
    v_cndmask_b32 v52, v52, v54, vcc
    v_cndmask_b32 v53, v53, v55, vcc
    v_and_b32 v1, 2, v65
    v_lshlrev_b32 v1, 3, v1
    v_sub_u32 v1, 16, v1
    s_mov_b32 s38, 0xc1200000
    s_mov_b32 s39, 0x3fb8aa3b
    v_lshlrev_b32 v56, 16, v52
    v_and_b32 v57, 0xffff0000, v52
    v_lshlrev_b32 v58, 16, v53
    v_and_b32 v59, 0xffff0000, v53
    s_waitcnt lgkmcnt(0)
    v_lshlrev_b32 v68, v1, v68
    v_lshlrev_b32 v70, v1, v70
    v_and_b32 v68, 0xffff0000, v68
    v_and_b32 v70, 0xffff0000, v70
    v_sub_f32 v52, v68, v56
    v_sub_f32 v53, v68, v57
    v_sub_f32 v54, v68, v58
    v_sub_f32 v55, v68, v59
    v_sub_f32 v56, v70, v56
    v_sub_f32 v57, v70, v57
    v_sub_f32 v58, v70, v58
    v_sub_f32 v59, v70, v59
    v_cvt_pk_bf16_f32 v68, v52, v53
    v_cvt_pk_bf16_f32 v69, v54, v55
    v_cvt_pk_bf16_f32 v70, v56, v57
    v_cvt_pk_bf16_f32 v71, v58, v59
    v_lshlrev_b32 v52, 16, v68
    v_and_b32 v53, 0xffff0000, v68
    v_lshlrev_b32 v54, 16, v69
    v_and_b32 v55, 0xffff0000, v69
    v_lshlrev_b32 v56, 16, v70
    v_and_b32 v57, 0xffff0000, v70
    v_lshlrev_b32 v58, 16, v71
    v_and_b32 v59, 0xffff0000, v71
    v_mul_f32 v52, v52, v52
    v_mul_f32 v53, v53, v53
    v_mul_f32 v54, v54, v54
    v_mul_f32 v55, v55, v55
    v_mul_f32 v56, v56, v56
    v_mul_f32 v57, v57, v57
    v_mul_f32 v58, v58, v58
    v_mul_f32 v59, v59, v59
    v_cvt_pk_bf16_f32 v68, v52, v53
    v_cvt_pk_bf16_f32 v69, v54, v55
    v_cvt_pk_bf16_f32 v70, v56, v57
    v_cvt_pk_bf16_f32 v71, v58, v59
    v_lshlrev_b32 v52, 16, v68
    v_and_b32 v53, 0xffff0000, v68
    v_lshlrev_b32 v54, 16, v69
    v_and_b32 v55, 0xffff0000, v69
    v_lshlrev_b32 v56, 16, v70
    v_and_b32 v57, 0xffff0000, v70
    v_lshlrev_b32 v58, 16, v71
    v_and_b32 v59, 0xffff0000, v71
    v_mul_f32 v52, s38, v52
    v_mul_f32 v53, s38, v53
    v_mul_f32 v54, s38, v54
    v_mul_f32 v55, s38, v55
    v_mul_f32 v56, s38, v56
    v_mul_f32 v57, s38, v57
    v_mul_f32 v58, s38, v58
    v_mul_f32 v59, s38, v59
    v_cvt_pk_bf16_f32 v68, v52, v53
    v_cvt_pk_bf16_f32 v69, v54, v55
    v_cvt_pk_bf16_f32 v70, v56, v57
    v_cvt_pk_bf16_f32 v71, v58, v59
    v_lshlrev_b32 v52, 16, v68
    v_and_b32 v53, 0xffff0000, v68
    v_lshlrev_b32 v54, 16, v69
    v_and_b32 v55, 0xffff0000, v69
    v_lshlrev_b32 v56, 16, v70
    v_and_b32 v57, 0xffff0000, v70
    v_lshlrev_b32 v58, 16, v71
    v_and_b32 v59, 0xffff0000, v71
    v_mul_f32 v52, s39, v52
    v_mul_f32 v53, s39, v53
    v_mul_f32 v54, s39, v54
    v_mul_f32 v55, s39, v55
    v_mul_f32 v56, s39, v56
    v_mul_f32 v57, s39, v57
    v_mul_f32 v58, s39, v58
    v_mul_f32 v59, s39, v59
    v_exp_f32 v52, v52
    v_exp_f32 v53, v53
    v_exp_f32 v54, v54
    v_exp_f32 v55, v55
    v_exp_f32 v56, v56
    v_exp_f32 v57, v57
    v_exp_f32 v58, v58
    v_exp_f32 v59, v59
    v_cvt_pk_bf16_f32 v68, v52, v53
    v_cvt_pk_bf16_f32 v69, v54, v55
    v_cvt_pk_bf16_f32 v70, v56, v57
    v_cvt_pk_bf16_f32 v71, v58, v59
    s_nop 1
    s_branch SDE_32
SD_33:
    s_nop 4
    v_and_b32 v0, 1, v65
    v_and_b32 v1, 0x2c, v65
    v_lshl_add_u32 v0, v0, 4, v1
    ds_bpermute_b32 v72, v0, v75 offset:128
    ds_bpermute_b32 v74, v0, v75 offset:192
    s_mov_b32 vcc_lo, 0xffff0000
    s_mov_b32 vcc_hi, 0xffff0000
    v_mov_b32 v52, s88
    v_mov_b32 v53, s89
    v_mov_b32 v54, s90
    v_mov_b32 v55, s91
    v_cndmask_b32 v52, v52, v54, vcc
    v_cndmask_b32 v53, v53, v55, vcc
    v_and_b32 v1, 2, v65
    v_lshlrev_b32 v1, 3, v1
    v_sub_u32 v1, 16, v1
    s_mov_b32 s38, 0xc1200000
    s_mov_b32 s39, 0x3fb8aa3b
    v_lshlrev_b32 v56, 16, v52
    v_and_b32 v57, 0xffff0000, v52
    v_lshlrev_b32 v58, 16, v53
    v_and_b32 v59, 0xffff0000, v53
    s_waitcnt lgkmcnt(0)
    v_lshlrev_b32 v72, v1, v72
    v_lshlrev_b32 v74, v1, v74
    v_and_b32 v72, 0xffff0000, v72
    v_and_b32 v74, 0xffff0000, v74
    v_sub_f32 v52, v72, v56
    v_sub_f32 v53, v72, v57
    v_sub_f32 v54, v72, v58
    v_sub_f32 v55, v72, v59
    v_sub_f32 v56, v74, v56
    v_sub_f32 v57, v74, v57
    v_sub_f32 v58, v74, v58
    v_sub_f32 v59, v74, v59
    v_cvt_pk_bf16_f32 v72, v52, v53
    v_cvt_pk_bf16_f32 v73, v54, v55
    v_cvt_pk_bf16_f32 v74, v56, v57
    v_cvt_pk_bf16_f32 v75, v58, v59
    v_lshlrev_b32 v52, 16, v72
    v_and_b32 v53, 0xffff0000, v72
    v_lshlrev_b32 v54, 16, v73
    v_and_b32 v55, 0xffff0000, v73
    v_lshlrev_b32 v56, 16, v74
    v_and_b32 v57, 0xffff0000, v74
    v_lshlrev_b32 v58, 16, v75
    v_and_b32 v59, 0xffff0000, v75
    v_mul_f32 v52, v52, v52
    v_mul_f32 v53, v53, v53
    v_mul_f32 v54, v54, v54
    v_mul_f32 v55, v55, v55
    v_mul_f32 v56, v56, v56
    v_mul_f32 v57, v57, v57
    v_mul_f32 v58, v58, v58
    v_mul_f32 v59, v59, v59
    v_cvt_pk_bf16_f32 v72, v52, v53
    v_cvt_pk_bf16_f32 v73, v54, v55
    v_cvt_pk_bf16_f32 v74, v56, v57
    v_cvt_pk_bf16_f32 v75, v58, v59
    v_lshlrev_b32 v52, 16, v72
    v_and_b32 v53, 0xffff0000, v72
    v_lshlrev_b32 v54, 16, v73
    v_and_b32 v55, 0xffff0000, v73
    v_lshlrev_b32 v56, 16, v74
    v_and_b32 v57, 0xffff0000, v74
    v_lshlrev_b32 v58, 16, v75
    v_and_b32 v59, 0xffff0000, v75
    v_mul_f32 v52, s38, v52
    v_mul_f32 v53, s38, v53
    v_mul_f32 v54, s38, v54
    v_mul_f32 v55, s38, v55
    v_mul_f32 v56, s38, v56
    v_mul_f32 v57, s38, v57
    v_mul_f32 v58, s38, v58
    v_mul_f32 v59, s38, v59
    v_cvt_pk_bf16_f32 v72, v52, v53
    v_cvt_pk_bf16_f32 v73, v54, v55
    v_cvt_pk_bf16_f32 v74, v56, v57
    v_cvt_pk_bf16_f32 v75, v58, v59
    v_lshlrev_b32 v52, 16, v72
    v_and_b32 v53, 0xffff0000, v72
    v_lshlrev_b32 v54, 16, v73
    v_and_b32 v55, 0xffff0000, v73
    v_lshlrev_b32 v56, 16, v74
    v_and_b32 v57, 0xffff0000, v74
    v_lshlrev_b32 v58, 16, v75
    v_and_b32 v59, 0xffff0000, v75
    v_mul_f32 v52, s39, v52
    v_mul_f32 v53, s39, v53
    v_mul_f32 v54, s39, v54
    v_mul_f32 v55, s39, v55
    v_mul_f32 v56, s39, v56
    v_mul_f32 v57, s39, v57
    v_mul_f32 v58, s39, v58
    v_mul_f32 v59, s39, v59
    v_exp_f32 v52, v52
    v_exp_f32 v53, v53
    v_exp_f32 v54, v54
    v_exp_f32 v55, v55
    v_exp_f32 v56, v56
    v_exp_f32 v57, v57
    v_exp_f32 v58, v58
    v_exp_f32 v59, v59
    v_cvt_pk_bf16_f32 v72, v52, v53
    v_cvt_pk_bf16_f32 v73, v54, v55
    v_cvt_pk_bf16_f32 v74, v56, v57
    v_cvt_pk_bf16_f32 v75, v58, v59
    s_nop 1
    s_branch SDE_34
POLL_37:
    ds_read_b32 v46, v67 offset:2064
    s_waitcnt lgkmcnt(0)
    v_readfirstlane_b32 s5, v46
    s_nop 0
    s_cmp_ge_u32 s5, s4
    s_cbranch_scc1 PDONE_38
    s_sleep 1
    s_branch POLL_37
SD_40:
    s_nop 4
    s_cmp_gt_u32 s24, 4
    s_cbranch_scc1 NOSS_108
    s_cmp_eq_u32 s24, 1
    s_cselect_b32 s38, 2.0, 1.0
    s_lshl_b32 s39, s24, 9
    v_lshlrev_b32 v20, 16, v20
    v_mul_f32 v20, s38, v20
    v_lshlrev_b32 v21, 16, v21
    v_mul_f32 v21, s38, v21
    v_lshlrev_b32 v22, 16, v22
    v_mul_f32 v22, s38, v22
    v_lshlrev_b32 v23, 16, v23
    v_mul_f32 v23, s38, v23
    v_cvt_pk_bf16_f32 v20, v20, v21
    v_cvt_pk_bf16_f32 v21, v22, v23
    v_lshl_add_u32 v0, v65, 3, s39
    ds_write_b64 v0, v[20:21] offset:2624
    s_nop 1
NOSS_108:
    s_branch SDE_41
SD_42:
    s_nop 4
    s_mul_i32 s38, s3, 50176
    s_lshl_b32 s39, s24, 8
    s_add_u32 s38, s38, s39
    v_lshrrev_b32 v0, 4, v65
    v_and_b32 v1, 15, v65
    v_lshlrev_b32 v62, 12, v0
    v_lshl_add_u32 v62, v1, 4, v62
    v_add_u32 v62, s38, v62
    s_mul_i32 s70, s24, 3072
    s_min_u32 s38, s24, 4
    s_lshl_b32 s38, s38, 8
    s_add_u32 s70, s70, s38
    s_add_u32 s70, s70, 59968
    v_lshl_add_u32 v61, v65, 4, s70
    v_lshl_add_u32 v60, v0, 3, s70
    v_and_b32 v0, 14, v65
    v_lshl_add_u32 v60, v0, 4, v60
    v_and_b32 v0, 1, v65
    v_lshl_add_u32 v60, v0, 8, v60
    v_add_u32 v0, 32768, v62
    s_add_u32 m0, s70, 2048
    s_nop 0
    buffer_load_dwordx4 v0, s[8:11], 0 offen lds
    s_branch SDE_43
RARE_45:
    s_nop 4
    s_bcnt1_i32_b64 s38, s[62:63]
    s_add_u32 s38, s38, s29
    s_cmp_gt_u32 s38, 44
    s_cselect_b32 s30, 1, s30
    s_cbranch_scc1 BACK_46
    s_mov_b64 exec, s[62:63]
    v_mbcnt_lo_u32_b32 v66, s62, 0
    v_mbcnt_hi_u32_b32 v66, s63, v66
    v_add_lshl_u32 v66, v66, s29, 3
    v_add_u32 v66, s34, v66
    s_mov_b32 s29, s38
    ds_write2_b32 v66, v54, v56 offset0:0 offset1:1
    s_nop 1
    s_branch BACK_46
RARE_49:
    s_nop 4
    s_bcnt1_i32_b64 s38, s[62:63]
    s_add_u32 s38, s38, s29
    s_cmp_gt_u32 s38, 44
    s_cselect_b32 s30, 1, s30
    s_cbranch_scc1 BACK_50
    s_mov_b64 exec, s[62:63]
    v_mbcnt_lo_u32_b32 v66, s62, 0
    v_mbcnt_hi_u32_b32 v66, s63, v66
    v_add_lshl_u32 v66, v66, s29, 3
    v_add_u32 v66, s34, v66
    s_mov_b32 s29, s38
    ds_write2_b32 v66, v28, v52 offset0:0 offset1:1
    s_nop 1
    s_branch BACK_50
RARE_51:
    s_nop 4
    s_bcnt1_i32_b64 s38, s[62:63]
    s_add_u32 s38, s38, s29
    s_cmp_gt_u32 s38, 44
    s_cselect_b32 s30, 1, s30
    s_cbranch_scc1 BACK_52
    s_mov_b64 exec, s[62:63]
    v_mbcnt_lo_u32_b32 v66, s62, 0
    v_mbcnt_hi_u32_b32 v66, s63, v66
    v_add_lshl_u32 v66, v66, s29, 3
    v_add_u32 v66, s34, v66
    s_mov_b32 s29, s38
    ds_write2_b32 v66, v30, v56 offset0:0 offset1:1
    s_nop 1
    s_branch BACK_52
LONG_53:
    s_nop 7
    v_add_u32 v62, 192, v62
    v_subrev_u32 v63, 192, v63
    s_nop 1
LLOOP_109:
    v_cmp_lt_i32 s[40:41], 0, v63
    v_cmp_lt_i32 s[42:43], 6, v63
    s_nop 0
    v_cndmask_b32 v0, -1, v62, s[40:41]
    buffer_load_dwordx3 v[28:30], v0, s[12:15], 0 offen
    v_add_u32 v62, 48, v62
    v_subrev_u32 v63, 48, v63
    s_waitcnt vmcnt(0)
    v_lshrrev_b32 v54, 24, v28
    v_lshl_add_u32 v55, v54, 2, s72
    v_lshrrev_b32 v58, 24, v30
    v_lshl_add_u32 v59, v58, 2, s72
    s_mov_b64 exec, s[40:41]
    ds_add_rtn_u32 v55, v55, v64
    s_mov_b64 exec, s[42:43]
    ds_add_rtn_u32 v59, v59, v64
    s_mov_b64 exec, -1
    v_lshlrev_b32 v52, 16, v29
    v_and_b32 v56, 0xffff0000, v29
    v_mul_f32 v52, 0.15915494, v52
    v_mul_f32 v56, 0.15915494, v56
    v_fract_f32 v52, v52
    v_fract_f32 v56, v56
    v_cos_f32 v52, v52
    v_cos_f32 v56, v56
    v_fma_f32 v0, v52, v52, -0.5
    v_fma_f32 v1, v56, v56, -0.5
    v_cvt_pk_bf16_f32 v52, v52, v0
    v_cvt_pk_bf16_f32 v56, v56, v1
    v_perm_b32 v53, v28, v28, s33
    v_perm_b32 v57, v30, v30, s33
    s_waitcnt lgkmcnt(0)
    s_mov_b64 exec, s[40:41]
    v_cmp_gt_u32 vcc, s26, v55
    v_mad_u32_u24 v55, v54, s31, v55
    s_andn2_b64 s[62:63], s[40:41], vcc
    s_cbranch_scc1 RARE_110
BACK_111:
    s_mov_b64 exec, vcc
    ds_write_b64 v55, v[52:53]
    s_mov_b64 exec, s[42:43]
    v_cmp_gt_u32 vcc, s26, v59
    v_mad_u32_u24 v59, v58, s31, v59
    s_andn2_b64 s[62:63], s[42:43], vcc
    s_cbranch_scc1 RARE_112
BACK_113:
    s_mov_b64 exec, vcc
    ds_write_b64 v59, v[56:57]
    s_mov_b64 exec, -1
    v_cmp_lt_i32 vcc, 0, v63
    s_cmp_lg_u32 s30, 0
    s_cbranch_scc1 LBACK_54
    s_nop 2
    s_cbranch_vccnz LLOOP_109
    s_branch LBACK_54
SD_55:
    s_nop 4
    s_cmp_lg_u32 s77, 0
    s_cbranch_scc1 MD_114
    v_add_u32 v0, 16384, v62
    s_add_u32 m0, s70, 1024
    s_nop 0
    buffer_load_dwordx4 v0, s[8:11], 0 offen lds
    s_branch MD_115
MD_114:
    buffer_load_dword v28, v67, s[8:11], 0 offen
MD_115:
    s_branch SDE_56
SD_57:
    s_nop 4
    v_lshlrev_b32 v37, 3, v65
    v_lshrrev_b32 v0, 1, v65
    v_lshlrev_b32 v0, 3, v0
    v_lshrrev_b32 v38, 2, v65
    v_lshlrev_b32 v38, 3, v38
    ds_read_u16 v36, v37 offset:2368
    ds_read_b32 v51, v0 offset:2116
    ds_read_b64_tr_b16 v[24:25], v38 offset:2112
    ds_read_b64_tr_b16 v[26:27], v38 offset:2240
    ds_read_b64_tr_b16 v[28:29], v38 offset:2368
    ds_read_b64_tr_b16 v[32:33], v38 offset:2496
    v_cmp_gt_u32 s[64:65], s71, v65
    s_lshl_b32 s38, s71, 5
    s_waitcnt lgkmcnt(0)
    v_and_b32 v0, 15, v36
    v_cmp_eq_u32 vcc, s24, v0
    s_nop 0
    s_and_b64 s[62:63], vcc, s[64:65]
    s_cbranch_scc0 LVE_116
    s_mov_b32 m0, s70
    v_lshrrev_b32 v51, 8, v51
    v_sub_u32 v1, s38, v31
    v_bfi_b32 v51, s32, v51, v1
    buffer_load_dwordx4 v51, s[8:11], 0 offen lds
    v_add_u32 v37, s70, v37
    v_mov_b32 v38, 0x10001
    v_and_b32_dpp v52, v24, v47 quad_perm:[2,2,2,2] row_mask:0xf bank_mask:0xf
    v_and_b32_dpp v53, v25, v47 quad_perm:[2,2,2,2] row_mask:0xf bank_mask:0xf
    v_and_b32_dpp v54, v26, v47 quad_perm:[2,2,2,2] row_mask:0xf bank_mask:0xf
    v_and_b32_dpp v55, v27, v47 quad_perm:[2,2,2,2] row_mask:0xf bank_mask:0xf
    v_perm_b32 v52, v3, v2, v52
    v_perm_b32 v53, v3, v2, v53
    v_perm_b32 v54, v3, v2, v54
    v_perm_b32 v55, v3, v2, v55
    v_and_b32_dpp v52, v24, v52 quad_perm:[0,1,0,1] row_mask:0xf bank_mask:0xf
    v_and_b32_dpp v53, v25, v53 quad_perm:[0,1,0,1] row_mask:0xf bank_mask:0xf
    v_and_b32_dpp v54, v26, v54 quad_perm:[0,1,0,1] row_mask:0xf bank_mask:0xf
    v_and_b32_dpp v55, v27, v55 quad_perm:[0,1,0,1] row_mask:0xf bank_mask:0xf
    s_waitcnt vmcnt(0)
    ds_read_b64_tr_b16 v[20:21], v37
    ds_read_b64_tr_b16 v[22:23], v37 offset:512
    s_waitcnt lgkmcnt(0)
    s_nop 0
LVL_117:
    s_ff1_i32_b64 s38, s[62:63]
    v_readlane_b32 s39, v36, s38
    s_nop 1
    v_cmp_eq_u32 vcc, s39, v36
    s_mul_i32 s38, s39, 0x10001
    s_andn2_b64 s[62:63], s[62:63], vcc
    s_lshr_b32 s39, s39, 4
    v_xor_b32 v56, s38, v28
    v_xor_b32 v57, s38, v29
    v_xor_b32 v58, s38, v32
    v_xor_b32 v59, s38, v33
    v_pk_min_u16 v56, v56, v38
    v_pk_min_u16 v57, v57, v38
    v_pk_min_u16 v58, v58, v38
    v_pk_min_u16 v59, v59, v38
    v_pk_sub_u16 v56, v56, v38
    v_pk_sub_u16 v57, v57, v38
    v_pk_sub_u16 v58, v58, v38
    v_pk_sub_u16 v59, v59, v38
    v_and_b32 v56, v56, v52
    v_and_b32 v57, v57, v53
    v_and_b32 v58, v58, v54
    v_and_b32 v59, v59, v55
    s_nop 1
    s_cmp_lg_u32 s39, 0
    s_cbranch_scc1 LVJ_119
    v_mfma_f32_16x16x32_bf16 v[76:79], v[20:23], v[56:59], v[76:79]
LVJ_119:
    s_cmp_lg_u32 s39, 1
    s_cbranch_scc1 LVJ_120
    v_mfma_f32_16x16x32_bf16 v[80:83], v[20:23], v[56:59], v[80:83]
LVJ_120:
    s_cmp_lg_u32 s39, 2
    s_cbranch_scc1 LVJ_121
    v_mfma_f32_16x16x32_bf16 v[84:87], v[20:23], v[56:59], v[84:87]
LVJ_121:
    s_cmp_lg_u32 s39, 3
    s_cbranch_scc1 LVJ_122
    v_mfma_f32_16x16x32_bf16 v[88:91], v[20:23], v[56:59], v[88:91]
LVJ_122:
    s_cmp_lg_u32 s39, 4
    s_cbranch_scc1 LVJ_123
    v_mfma_f32_16x16x32_bf16 v[92:95], v[20:23], v[56:59], v[92:95]
LVJ_123:
    s_cmp_lg_u32 s39, 5
    s_cbranch_scc1 LVJ_124
    v_mfma_f32_16x16x32_bf16 v[96:99], v[20:23], v[56:59], v[96:99]
LVJ_124:
    s_cmp_lg_u32 s39, 6
    s_cbranch_scc1 LVJ_125
    v_mfma_f32_16x16x32_bf16 v[100:103], v[20:23], v[56:59], v[100:103]
LVJ_125:
    s_cmp_lg_u32 s39, 7
    s_cbranch_scc1 LVJ_126
    v_mfma_f32_16x16x32_bf16 v[104:107], v[20:23], v[56:59], v[104:107]
LVJ_126:
    s_cmp_lg_u32 s39, 8
    s_cbranch_scc1 LVJ_127
    v_mfma_f32_16x16x32_bf16 v[108:111], v[20:23], v[56:59], v[108:111]
LVJ_127:
    s_cmp_lg_u32 s39, 9
    s_cbranch_scc1 LVJ_128
    v_mfma_f32_16x16x32_bf16 v[112:115], v[20:23], v[56:59], v[112:115]
LVJ_128:
    s_cmp_lg_u32 s39, 10
    s_cbranch_scc1 LVJ_129
    v_mfma_f32_16x16x32_bf16 v[116:119], v[20:23], v[56:59], v[116:119]
LVJ_129:
    s_cmp_lg_u32 s39, 11
    s_cbranch_scc1 LVJ_130
    v_mfma_f32_16x16x32_bf16 v[120:123], v[20:23], v[56:59], v[120:123]
LVJ_130:
    s_cmp_lg_u32 s39, 12
    s_cbranch_scc1 LVJ_131
    v_mfma_f32_16x16x32_bf16 v[124:127], v[20:23], v[56:59], v[124:127]
LVJ_131:
    s_nop 7
    s_cmp_lg_u64 s[62:63], 0
    s_cbranch_scc1 LVL_117
LVE_116:
    s_branch SDE_58
RARE_61:
    s_nop 4
    s_bcnt1_i32_b64 s38, s[62:63]
    s_add_u32 s38, s38, s29
    s_cmp_gt_u32 s38, 44
    s_cselect_b32 s30, 1, s30
    s_cbranch_scc1 BACK_62
    s_mov_b64 exec, s[62:63]
    v_mbcnt_lo_u32_b32 v66, s62, 0
    v_mbcnt_hi_u32_b32 v66, s63, v66
    v_add_lshl_u32 v66, v66, s29, 3
    v_add_u32 v66, s34, v66
    s_mov_b32 s29, s38
    ds_write2_b32 v66, v32, v52 offset0:0 offset1:1
    s_nop 1
    s_branch BACK_62
RARE_63:
    s_nop 4
    s_bcnt1_i32_b64 s38, s[62:63]
    s_add_u32 s38, s38, s29
    s_cmp_gt_u32 s38, 44
    s_cselect_b32 s30, 1, s30
    s_cbranch_scc1 BACK_64
    s_mov_b64 exec, s[62:63]
    v_mbcnt_lo_u32_b32 v66, s62, 0
    v_mbcnt_hi_u32_b32 v66, s63, v66
    v_add_lshl_u32 v66, v66, s29, 3
    v_add_u32 v66, s34, v66
    s_mov_b32 s29, s38
    ds_write2_b32 v66, v34, v56 offset0:0 offset1:1
    s_nop 1
    s_branch BACK_64
SD_65:
    s_nop 4
    s_cmp_lg_u32 s77, 0
    s_cbranch_scc1 MD_132
    v_add_u32 v0, 49152, v62
    s_add_u32 m0, s70, 3072
    s_cmp_lt_u32 s24, 4
    s_cselect_b32 m0, m0, s70
    s_cselect_b32 s38, 0, 49152
    v_subrev_u32 v0, s38, v0
    s_mov_b64 exec, 0xffff
    buffer_load_dwordx4 v0, s[8:11], 0 offen lds
    s_mov_b64 exec, -1
    s_branch MD_133
MD_132:
    buffer_load_dword v32, v67, s[8:11], 0 offen
MD_133:
    s_branch SDE_66
RARE_70:
    s_nop 4
    s_bcnt1_i32_b64 s38, s[62:63]
    s_add_u32 s38, s38, s29
    s_cmp_gt_u32 s38, 44
    s_cselect_b32 s30, 1, s30
    s_cbranch_scc1 BACK_71
    s_mov_b64 exec, s[62:63]
    v_mbcnt_lo_u32_b32 v66, s62, 0
    v_mbcnt_hi_u32_b32 v66, s63, v66
    v_add_lshl_u32 v66, v66, s29, 3
    v_add_u32 v66, s34, v66
    s_mov_b32 s29, s38
    ds_write2_b32 v66, v36, v52 offset0:0 offset1:1
    s_nop 1
    s_branch BACK_71
RARE_72:
    s_nop 4
    s_bcnt1_i32_b64 s38, s[62:63]
    s_add_u32 s38, s38, s29
    s_cmp_gt_u32 s38, 44
    s_cselect_b32 s30, 1, s30
    s_cbranch_scc1 BACK_73
    s_mov_b64 exec, s[62:63]
    v_mbcnt_lo_u32_b32 v66, s62, 0
    v_mbcnt_hi_u32_b32 v66, s63, v66
    v_add_lshl_u32 v66, v66, s29, 3
    v_add_u32 v66, s34, v66
    s_mov_b32 s29, s38
    ds_write2_b32 v66, v38, v56 offset0:0 offset1:1
    s_nop 1
    s_branch BACK_73
SD_74:
    s_nop 4
    s_cmp_lg_u32 s77, 0
    s_cbranch_scc1 MD_134
    v_add_u32 v0, 0, v62
    s_add_u32 m0, s70, 0
    s_nop 0
    buffer_load_dwordx4 v0, s[8:11], 0 offen lds
    s_branch MD_135
MD_134:
    buffer_load_dword v36, v67, s[8:11], 0 offen
MD_135:
    s_branch SDE_75
RARE_78:
    s_nop 4
    s_bcnt1_i32_b64 s38, s[62:63]
    s_add_u32 s38, s38, s29
    s_cmp_gt_u32 s38, 44
    s_cselect_b32 s30, 1, s30
    s_cbranch_scc1 BACK_79
    s_mov_b64 exec, s[62:63]
    v_mbcnt_lo_u32_b32 v66, s62, 0
    v_mbcnt_hi_u32_b32 v66, s63, v66
    v_add_lshl_u32 v66, v66, s29, 3
    v_add_u32 v66, s34, v66
    s_mov_b32 s29, s38
    ds_write2_b32 v66, v40, v52 offset0:0 offset1:1
    s_nop 1
    s_branch BACK_79
RARE_80:
    s_nop 4
    s_bcnt1_i32_b64 s38, s[62:63]
    s_add_u32 s38, s38, s29
    s_cmp_gt_u32 s38, 44
    s_cselect_b32 s30, 1, s30
    s_cbranch_scc1 BACK_81
    s_mov_b64 exec, s[62:63]
    v_mbcnt_lo_u32_b32 v66, s62, 0
    v_mbcnt_hi_u32_b32 v66, s63, v66
    v_add_lshl_u32 v66, v66, s29, 3
    v_add_u32 v66, s34, v66
    s_mov_b32 s29, s38
    ds_write2_b32 v66, v42, v56 offset0:0 offset1:1
    s_nop 1
    s_branch BACK_81
SD_82:
    s_nop 4
    v_mov_b32 v0, s38
    v_lshl_add_u32 v1, v65, 3, s34
    s_mov_b64 exec, 1
    ds_add_rtn_u32 v0, v67, v0 offset:2048
    s_mov_b64 exec, -1
    ds_read_b32 v54, v1
    ds_read_b32 v52, v1 offset:4
    s_mov_b32 s39, 0x10001
    v_cmp_gt_u32 s[62:63], s29, v65
    s_waitcnt lgkmcnt(0)
    v_readfirstlane_b32 s38, v0
    v_perm_b32 v53, v54, v54, s33
    v_lshrrev_b32 v56, 24, v54
    s_and_b32 s38, s38, 0xffff
    v_mul_u32_u24 v56, s39, v56
    v_add_u32 v1, s38, v65
    v_mov_b32 v57, v56
    v_cmp_gt_u32 vcc, 32, v1
    v_lshlrev_b32 v1, 3, v1
    s_and_b64 exec, vcc, s[62:63]
    ds_write_b64 v1, v[52:53] offset:2112
    ds_write_b64 v1, v[56:57] offset:2368
    s_mov_b64 exec, -1
    s_nop 0
    s_branch SDE_83
SD_84:
    s_nop 4
    s_cmp_lg_u32 s77, 0
    s_cbranch_scc1 MD_136
    v_add_u32 v0, 0, v62
    s_add_u32 m0, s70, 0
    s_nop 0
    buffer_load_dwordx4 v0, s[8:11], 0 offen lds
    s_branch MD_137
MD_136:
    buffer_load_dword v40, v67, s[8:11], 0 offen
MD_137:
    s_branch SDE_85
K2_GEN0:
    s_nop 7
    s_waitcnt vmcnt(2)
    ds_read_b64_tr_b16 v[20:21], v48
    ds_read_b64_tr_b16 v[22:23], v48 offset:512
    s_waitcnt lgkmcnt(0)
    v_mfma_f32_16x16x32_bf16 v[84:87], v[20:23], v[8:11], v[84:87]
    s_waitcnt vmcnt(1)
    ds_read_b64_tr_b16 v[20:21], v49
    ds_read_b64_tr_b16 v[22:23], v49 offset:512
    s_waitcnt lgkmcnt(0)
    v_mfma_f32_16x16x32_bf16 v[80:83], v[20:23], v[12:15], v[80:83]
    s_waitcnt vmcnt(0)
    ds_read_b64_tr_b16 v[20:21], v50
    ds_read_b64_tr_b16 v[22:23], v50 offset:512
    s_waitcnt lgkmcnt(0)
    v_mfma_f32_16x16x32_bf16 v[76:79], v[20:23], v[16:19], v[76:79]
    s_nop 7
    s_branch K2_GEN
K2_EPI:
    s_waitcnt vmcnt(0)
    s_cmp_ge_u32 s24, 4
    s_cbranch_scc1 K2_EPI_A
    v_cvt_pk_bf16_f32 v52, v124, v125
    v_cvt_pk_bf16_f32 v53, v126, v127
    v_cvt_pk_bf16_f32 v56, v124, v125
    v_cvt_pk_bf16_f32 v57, v126, v127
    v_add_u32 v38, 3072, v60
    s_mov_b32 s62, -1
    s_mov_b32 s63, 0
    v_cndmask_b32 v36, 0, v74, s[62:63]
    v_cndmask_b32 v37, 0, v75, s[62:63]
    s_mov_b64 s[64:65], 0x55555555
    s_mov_b32 s65, 0x55555555
    s_call_b64 s[98:99], K2_PAIR
    s_mov_b64 exec, 0xffff
    ds_read_b128 v[52:55], v61 offset:3072
    v_add_u32 v51, 49152, v62
    s_waitcnt lgkmcnt(0)
    buffer_store_dwordx4 v[52:55], v51, s[16:19], 0 offen sc0 sc1
    s_mov_b64 exec, -1
    s_nop 0
K2_EPI_A:
    v_cvt_pk_bf16_f32 v52, v116, v117
    v_cvt_pk_bf16_f32 v53, v118, v119
    v_cvt_pk_bf16_f32 v56, v120, v121
    v_cvt_pk_bf16_f32 v57, v122, v123
    v_add_u32 v38, 2560, v60
    s_mov_b32 s63, -1
    s_mov_b32 s62, 0
    v_cndmask_b32 v36, 0, v72, s[62:63]
    v_cndmask_b32 v37, 0, v73, s[62:63]
    s_mov_b64 s[64:65], -1
    s_call_b64 s[98:99], K2_PAIR
    v_cvt_pk_bf16_f32 v52, v108, v109
    v_cvt_pk_bf16_f32 v53, v110, v111
    v_cvt_pk_bf16_f32 v56, v112, v113
    v_cvt_pk_bf16_f32 v57, v114, v115
    v_add_u32 v38, 2048, v60
    s_mov_b32 s62, -1
    s_mov_b32 s63, 0
    v_cndmask_b32 v36, 0, v72, s[62:63]
    v_cndmask_b32 v37, 0, v73, s[62:63]
    s_mov_b64 s[64:65], -1
    s_call_b64 s[98:99], K2_PAIR
    ds_read_b128 v[52:55], v61 offset:2048
    v_add_u32 v51, 32768, v62
    s_waitcnt lgkmcnt(0)
    buffer_store_dwordx4 v[52:55], v51, s[16:19], 0 offen sc0 sc1
    s_nop 1
    v_cvt_pk_bf16_f32 v52, v100, v101
    v_cvt_pk_bf16_f32 v53, v102, v103
    v_cvt_pk_bf16_f32 v56, v104, v105
    v_cvt_pk_bf16_f32 v57, v106, v107
    v_add_u32 v38, 1536, v60
    s_mov_b32 s63, -1
    s_mov_b32 s62, 0
    v_cndmask_b32 v36, 0, v70, s[62:63]
    v_cndmask_b32 v37, 0, v71, s[62:63]
    s_mov_b64 s[64:65], -1
    s_call_b64 s[98:99], K2_PAIR
    v_cvt_pk_bf16_f32 v52, v92, v93
    v_cvt_pk_bf16_f32 v53, v94, v95
    v_cvt_pk_bf16_f32 v56, v96, v97
    v_cvt_pk_bf16_f32 v57, v98, v99
    v_add_u32 v38, 1024, v60
    s_mov_b32 s62, -1
    s_mov_b32 s63, 0
    v_cndmask_b32 v36, 0, v70, s[62:63]
    v_cndmask_b32 v37, 0, v71, s[62:63]
    s_mov_b64 s[64:65], -1
    s_call_b64 s[98:99], K2_PAIR
    ds_read_b128 v[52:55], v61 offset:1024
    v_add_u32 v51, 16384, v62
    s_waitcnt lgkmcnt(0)
    buffer_store_dwordx4 v[52:55], v51, s[16:19], 0 offen sc0 sc1
    s_nop 1
    v_cvt_pk_bf16_f32 v52, v84, v85
    v_cvt_pk_bf16_f32 v53, v86, v87
    v_cvt_pk_bf16_f32 v56, v88, v89
    v_cvt_pk_bf16_f32 v57, v90, v91
    v_add_u32 v38, 512, v60
    s_mov_b32 s63, -1
    s_mov_b32 s62, 0
    v_cndmask_b32 v36, 0, v68, s[62:63]
    v_cndmask_b32 v37, 0, v69, s[62:63]
    s_mov_b64 s[64:65], -1
    s_call_b64 s[98:99], K2_PAIR
    s_branch K2_EPI_B
RARE_104:
    s_nop 4
    s_bcnt1_i32_b64 s38, s[62:63]
    s_add_u32 s38, s38, s29
    s_cmp_gt_u32 s38, 44
    s_cselect_b32 s30, 1, s30
    s_cbranch_scc1 BACK_105
    s_mov_b64 exec, s[62:63]
    v_mbcnt_lo_u32_b32 v66, s62, 0
    v_mbcnt_hi_u32_b32 v66, s63, v66
    v_add_lshl_u32 v66, v66, s29, 3
    v_add_u32 v66, s34, v66
    s_mov_b32 s29, s38
    ds_write2_b32 v66, v28, v52 offset0:0 offset1:1
    s_nop 1
    s_branch BACK_105
RARE_106:
    s_nop 4
    s_bcnt1_i32_b64 s38, s[62:63]
    s_add_u32 s38, s38, s29
    s_cmp_gt_u32 s38, 44
    s_cselect_b32 s30, 1, s30
    s_cbranch_scc1 BACK_107
    s_mov_b64 exec, s[62:63]
    v_mbcnt_lo_u32_b32 v66, s62, 0
    v_mbcnt_hi_u32_b32 v66, s63, v66
    v_add_lshl_u32 v66, v66, s29, 3
    v_add_u32 v66, s34, v66
    s_mov_b32 s29, s38
    ds_write2_b32 v66, v30, v56 offset0:0 offset1:1
    s_nop 1
    s_branch BACK_107
RARE_110:
    s_nop 4
    s_bcnt1_i32_b64 s38, s[62:63]
    s_add_u32 s38, s38, s29
    s_cmp_gt_u32 s38, 44
    s_cselect_b32 s30, 1, s30
    s_cbranch_scc1 BACK_111
    s_mov_b64 exec, s[62:63]
    v_mbcnt_lo_u32_b32 v66, s62, 0
    v_mbcnt_hi_u32_b32 v66, s63, v66
    v_add_lshl_u32 v66, v66, s29, 3
    v_add_u32 v66, s34, v66
    s_mov_b32 s29, s38
    ds_write2_b32 v66, v28, v52 offset0:0 offset1:1
    s_nop 1
    s_branch BACK_111
RARE_112:
    s_nop 4
    s_bcnt1_i32_b64 s38, s[62:63]
    s_add_u32 s38, s38, s29
    s_cmp_gt_u32 s38, 44
    s_cselect_b32 s30, 1, s30
    s_cbranch_scc1 BACK_113
    s_mov_b64 exec, s[62:63]
    v_mbcnt_lo_u32_b32 v66, s62, 0
    v_mbcnt_hi_u32_b32 v66, s63, v66
    v_add_lshl_u32 v66, v66, s29, 3
    v_add_u32 v66, s34, v66
    s_mov_b32 s29, s38
    ds_write2_b32 v66, v30, v56 offset0:0 offset1:1
    s_nop 1
    s_branch BACK_113
TEXT_END:
.section .rodata,"a"
.p2align 6
.amdhsa_kernel gs_bin_kernel
  .amdhsa_next_free_vgpr 112
  .amdhsa_next_free_sgpr 100
  .amdhsa_accum_offset 112
  .amdhsa_group_segment_fixed_size 0
  .amdhsa_kernarg_size 112
  .amdhsa_user_sgpr_count 2
  .amdhsa_user_sgpr_kernarg_segment_ptr 1
  .amdhsa_system_sgpr_workgroup_id_x 1
.end_amdhsa_kernel
.section .rodata,"a"
.p2align 6
.amdhsa_kernel gather_scatter__molecular_angular_gemnet__graph_kernel
  .amdhsa_next_free_vgpr 128
  .amdhsa_next_free_sgpr 102
  .amdhsa_accum_offset 128
  .amdhsa_group_segment_fixed_size 0
  .amdhsa_kernarg_size 112
  .amdhsa_user_sgpr_count 2
  .amdhsa_user_sgpr_kernarg_segment_ptr 1
  .amdhsa_system_sgpr_workgroup_id_x 1
.end_amdhsa_kernel
```
